```python
import torch

def _softmax(x, axis=-1):
    return torch.softmax(x, dim=axis)
def _gelu(x):
    return torch.nn.functional.gelu(x, approximate="tanh")
def _silu(x):
    return torch.nn.functional.silu(x)
def _sigmoid(x):
    return torch.sigmoid(x)
def _layernorm(x, axis=-1, eps=1e-5):
    m = x.mean(dim=axis, keepdim=True)
    v = x.var(dim=axis, keepdim=True, unbiased=False)
    return (x - m) / torch.sqrt(v + eps)
def _scatter_add(tgt, idx, src, axis=0):
    return tgt.clone().index_add_(axis, idx, src)
def _segment_sum(src, seg, n):
    out = torch.zeros((n,) + src.shape[1:], dtype=src.dtype)
    return out.index_add_(0, seg, src)
def _pad(x, pw):
    flat = tuple(v for pair in reversed(pw) for v in pair)
    return torch.nn.functional.pad(x, flat)

kernel_name = 'concat_heads__gqa_block_cached__compressed_kv_cla__decode'

def setup_inputs():

    _w = (lambda a: (lambda t: t.to(torch.bfloat16) if t.is_floating_point() else t)(torch.as_tensor(a)))
    def _A_setup():
        B, Sq, D = 1, 1, 448
        Hq, Hkv, Sk, Dh = 16, 8, 8192, 256
        assert Hq % Hkv == 0, (Hq, Hkv)
        return {
            "x": _w((lambda *s: torch.randn(*s, dtype=torch.bfloat16) * 1.6)(B, Sq, D)),
            "k_cache": _w((lambda *s: torch.randn(*s, dtype=torch.bfloat16) * 1.6)(B, Hkv, Sk, Dh)),
            "v_cache": _w((lambda *s: torch.randn(*s, dtype=torch.bfloat16) * 0.05)(B, Hkv, Sk, Dh)),
            "wq": _w((lambda *s: torch.randn(*s, dtype=torch.bfloat16) * 1.6)(D, Hq * Dh) * (D ** -0.5)),
            "wo": _w((lambda *s: torch.randn(*s, dtype=torch.bfloat16) * 0.05)(Hq * Dh, D) * ((Hq * Dh) ** -0.5)),
        }
    _A_in = _A_setup()

    def _B_setup():
        B, H, Sq, Sk, D, M = 1, 16, 1, 8192, 256, 448
        Dc = 4 * D
        return {
            "x": _w((lambda *s: torch.randn(*s, dtype=torch.bfloat16) * 3.2)(B, Sq, M)),
            "c_kv": _w((lambda *s: torch.randn(*s, dtype=torch.bfloat16) * 0.1)(B, Sk, Dc)),
            "w_q": _w((lambda *s: torch.randn(*s, dtype=torch.bfloat16) * 6.4)(M, H, D) * (M ** -0.5)),
            "w_uk": _w((lambda *s: torch.randn(*s, dtype=torch.bfloat16) * 6.4)(Dc, H, D) * (Dc ** -0.5)),
            "w_uv": _w((lambda *s: torch.randn(*s, dtype=torch.bfloat16) * 0.1)(Dc, H, D) * (Dc ** -0.5)),
            "w_o": _w((lambda *s: torch.randn(*s, dtype=torch.bfloat16) * 0.1)(H, D, M) * ((H * D) ** -0.5)),
        }
    _B_in = _B_setup()

    return {
        "A_x": _A_in["x"],
        "A_k_cache": _A_in["k_cache"],
        "A_v_cache": _A_in["v_cache"],
        "A_wq": _A_in["wq"],
        "A_wo": _A_in["wo"],
        "B_x": _B_in["x"],
        "B_c_kv": _B_in["c_kv"],
        "B_w_q": _B_in["w_q"],
        "B_w_uk": _B_in["w_uk"],
        "B_w_uv": _B_in["w_uv"],
        "B_w_o": _B_in["w_o"],
    }

def reference(A_x, A_k_cache, A_v_cache, A_wq, A_wo, B_x, B_c_kv, B_w_q, B_w_uk, B_w_uv, B_w_o):
    def _A_ref(x, k_cache, v_cache, wq, wo):
        B, Sq, D = x.shape
        Hq, Dh = 16, 256
        Hkv = k_cache.shape[1]
        rep = Hq // Hkv
        q = (lambda x, *d: x.permute(*d))((x @ wq).reshape(B, Sq, Hq, Dh), 0, 2, 1, 3)
        k = (lambda x, n, axis: torch.repeat_interleave(x, n, dim=axis))(k_cache, rep, axis=1)
        v = (lambda x, n, axis: torch.repeat_interleave(x, n, dim=axis))(v_cache, rep, axis=1)
        scores = torch.einsum("bhqd,bhkd->bhqk", q, k) * (Dh ** -0.5)
        p = _softmax(scores, axis=-1)
        o = torch.einsum("bhqk,bhkd->bhqd", p, v)
        return (lambda x, *d: x.permute(*d))(o, 0, 2, 1, 3).reshape(B, Sq, Hq * Dh) @ wo

    def _B_ref(x, c_kv, w_q, w_uk, w_uv, w_o):
        B, Sq, M = x.shape[0], x.shape[1], x.shape[2]
        Sk = c_kv.shape[1]
        H, D = w_q.shape[1], w_q.shape[2]
        q = torch.einsum("bqm,mhd->bhqd", x, w_q)
        k = torch.einsum("bkc,chd->bhkd", c_kv, w_uk)
        v = torch.einsum("bkc,chd->bhkd", c_kv, w_uv)
        scores = torch.einsum("bhqd,bhkd->bhqk", q, k) * (D ** -0.5)
        off = Sk - Sq
        qi = torch.arange(Sq)[:, None]
        kj = torch.arange(Sk)[None, :]
        cmask = kj <= (qi + off)
        scores = torch.where(cmask[None, None], scores, -1e9)
        p = _softmax(scores, axis=-1)
        ctx = torch.einsum("bhqk,bhkd->bhqd", p, v)
        return torch.einsum("bhqd,hdm->bqm", ctx, w_o)

    a = _A_ref(A_x, A_k_cache, A_v_cache, A_wq, A_wo)
    b = _B_ref(B_x, B_c_kv, B_w_q, B_w_uk, B_w_uv, B_w_o)
    return torch.concatenate([a, b], axis=-1)
```

```asm
; @launch grid=(256,1,1) block=(512,1,1) lds=163840
.amdgcn_target "amdgcn-amd-amdhsa--gfx950"
.text
.globl concat_heads__gqa_block_cached__compressed_kv_cla__decode_kernel
.p2align 10
.p2align 8
.type concat_heads__gqa_block_cached__compressed_kv_cla__decode_kernel,@function
concat_heads__gqa_block_cached__compressed_kv_cla__decode_kernel:
s_cmp_ge_u32 s2, 256
s_cbranch_scc1 L_end
s_load_dwordx16 s[36:51], s[0:1], 0
s_load_dwordx8 s[52:59], s[0:1], 64
s_load_dwordx4 s[60:63], s[0:1], 96
v_lshrrev_b32 v13, 6, v0
v_and_b32 v1, 63, v0
v_readfirstlane_b32 s3, v13
s_cmp_lt_u32 s2, 128
s_cbranch_scc1 L_PQ
s_cmp_lt_u32 s2, 192
s_cbranch_scc1 L_A0
s_cmp_ge_u32 s3, 4
s_cbranch_scc1 C_B
s_sub_u32 s28, s2, 192
s_lshl_b32 s28, s28, 18
s_lshl_b32 s65, s3, 14
s_add_u32 s64, s28, s65
s_and_b32 s28, s3, 1
s_lshl_b32 s28, s28, 4
v_lshlrev_b32 v110, 4, v1
v_xor_b32 v110, s28, v110
s_waitcnt lgkmcnt(0)
s_mov_b32 s4, s48
s_mov_b32 s5, s49
s_mov_b32 s6, 16777216
s_mov_b32 s7, 0x00020000
v_xor_b32 v23, 0, v110
s_add_u32 m0, s65, 0
s_add_u32 s28, s64, 0
buffer_load_dwordx4 v23, s[4:7], s28 offen offset:0 nt lds
buffer_load_dwordx4 v23, s[4:7], s28 offen offset:1024 nt lds
v_xor_b32 v23, 32, v110
s_add_u32 m0, s65, 2048
s_add_u32 s28, s64, 2048
buffer_load_dwordx4 v23, s[4:7], s28 offen offset:0 nt lds
buffer_load_dwordx4 v23, s[4:7], s28 offen offset:1024 nt lds
v_xor_b32 v23, 64, v110
s_add_u32 m0, s65, 4096
s_add_u32 s28, s64, 4096
buffer_load_dwordx4 v23, s[4:7], s28 offen offset:0 nt lds
buffer_load_dwordx4 v23, s[4:7], s28 offen offset:1024 nt lds
v_xor_b32 v23, 96, v110
s_add_u32 m0, s65, 6144
s_add_u32 s28, s64, 6144
buffer_load_dwordx4 v23, s[4:7], s28 offen offset:0 nt lds
buffer_load_dwordx4 v23, s[4:7], s28 offen offset:1024 nt lds
s_branch L_S
L_A0:
v_lshrrev_b32 v21, 5, v1
v_and_b32 v20, 31, v1
v_xor_b32 v20, v20, v21
v_lshlrev_b32 v20, 4, v20
v_lshl_add_u32 v20, v21, 13, v20
s_and_b32 s34, s2, 3
s_lshl_b32 s34, s34, 21
s_bfe_u32 s35, s2, 0x40002
s_lshl_b32 s35, s35, 9
s_add_u32 s34, s34, s35
s_lshl_b32 s35, s3, 18
s_add_u32 s34, s34, s35
s_lshl_b32 s35, s3, 14
s_waitcnt lgkmcnt(0)
s_mov_b32 s4, s52
s_mov_b32 s5, s53
s_mov_b32 s6, 8388608
s_mov_b32 s7, 0x00020000
v_xor_b32 v21, 0, v20
s_add_u32 m0, s35, 0
s_nop 0
buffer_load_dwordx4 v21, s[4:7], s34 offen nt lds
s_add_u32 s34, s34, 16384
v_xor_b32 v21, 32, v20
s_add_u32 m0, s35, 1024
s_nop 0
buffer_load_dwordx4 v21, s[4:7], s34 offen nt lds
s_add_u32 s34, s34, 16384
v_xor_b32 v21, 64, v20
s_add_u32 m0, s35, 2048
s_nop 0
buffer_load_dwordx4 v21, s[4:7], s34 offen nt lds
s_add_u32 s34, s34, 16384
v_xor_b32 v21, 96, v20
s_add_u32 m0, s35, 3072
s_nop 0
buffer_load_dwordx4 v21, s[4:7], s34 offen nt lds
s_add_u32 s34, s34, 16384
s_cmp_ge_u32 s3, 4
s_cbranch_scc1 C_A
s_branch S_A
L_PQ:
s_cmp_lt_u32 s3, 4
s_cbranch_scc1 L_SP
s_sub_u32 s30, s3, 4
v_lshrrev_b32 v20, 3, v1
v_mul_u32_u24 v21, 28, v20
s_mul_i32 s32, s30, 224
v_mul_u32_u24 v20, 114688, v20
v_and_b32 v22, 7, v1
v_lshl_add_u32 v20, v22, 4, v20
s_mul_i32 s28, s30, 917504
s_and_b32 s35, s2, 63
s_lshl_b32 s29, s35, 7
s_add_u32 s28, s28, s29
s_mov_b32 s6, 3670016
s_mov_b32 s7, 0x00020000
s_movk_i32 s10, 896
s_mov_b32 s11, 0x00020000
s_cmp_lt_u32 s2, 64
s_waitcnt lgkmcnt(0)
s_cselect_b32 s4, s50, s42
s_cselect_b32 s5, s51, s43
s_cselect_b32 s8, s46, s36
s_cselect_b32 s9, s47, s37
buffer_load_dwordx4 v[24:27], v21, s[8:11], s32 offen
buffer_load_dwordx3 v[28:30], v21, s[8:11], s32 offen offset:16
s_cmp_lt_u32 s2, 64
s_cbranch_scc1 PD_1
s_waitcnt vmcnt(0)
PD_1:
buffer_load_dwordx4 v[192:195], v20, s[4:7], s28 offen nt
s_add_u32 s28, s28, 8192
s_cmp_lt_u32 s2, 64
s_cbranch_scc1 PD_2
s_waitcnt vmcnt(0)
PD_2:
buffer_load_dwordx4 v[196:199], v20, s[4:7], s28 offen nt
s_add_u32 s28, s28, 8192
buffer_load_dwordx4 v[200:203], v20, s[4:7], s28 offen nt
s_add_u32 s28, s28, 8192
buffer_load_dwordx4 v[204:207], v20, s[4:7], s28 offen nt
s_add_u32 s28, s28, 8192
buffer_load_dwordx4 v[208:211], v20, s[4:7], s28 offen nt
s_add_u32 s28, s28, 8192
buffer_load_dwordx4 v[212:215], v20, s[4:7], s28 offen nt
s_add_u32 s28, s28, 8192
buffer_load_dwordx4 v[216:219], v20, s[4:7], s28 offen nt
s_add_u32 s28, s28, 8192
buffer_load_dwordx4 v[220:223], v20, s[4:7], s28 offen nt
s_add_u32 s28, s28, 8192
buffer_load_dwordx4 v[224:227], v20, s[4:7], s28 offen nt
s_add_u32 s28, s28, 8192
buffer_load_dwordx4 v[228:231], v20, s[4:7], s28 offen nt
s_add_u32 s28, s28, 8192
buffer_load_dwordx4 v[232:235], v20, s[4:7], s28 offen nt
s_add_u32 s28, s28, 8192
buffer_load_dwordx4 v[236:239], v20, s[4:7], s28 offen nt
s_add_u32 s28, s28, 8192
buffer_load_dwordx4 v[240:243], v20, s[4:7], s28 offen nt
s_add_u32 s28, s28, 8192
buffer_load_dwordx4 v[244:247], v20, s[4:7], s28 offen nt
s_branch C_P1
L_SP:
s_cmp_lt_u32 s2, 64
s_cbranch_scc1 S_P
s_getpc_b64 s[4:5]
s_and_b32 s4, s4, 0xfffffc00
s_mov_b32 s6, CODE_BYTES
s_mov_b32 s7, 0x00020000
s_bfe_u32 s28, s2, 0x10003
s_lshl_b32 s28, s28, 2
s_add_u32 s28, s28, s3
s_lshl_b32 s28, s28, 13
v_lshlrev_b32 v14, 7, v1
buffer_load_dword v255, v14, s[4:7], s28 offen
s_branch S_P
L_hotend:
C_P1:
v_mov_b32 v12, 0
v_mov_b32 v2, 163072
v_mov_b32 v3, 1
s_bfe_u32 s101, s2, 0x20003
s_and_b32 s28, s2, 7
s_and_b32 s31, s2, 0xc0
s_lshl_b32 s28, s28, 3
s_add_u32 s31, s31, s28
s_bfe_u32 s28, s2, 0x30003
s_add_u32 s31, s31, s28
v_mov_b32 v0, s31
s_setprio 3
s_sub_u32 s3, s3, 4
s_waitcnt lgkmcnt(0)
s_mov_b32 s12, s62
s_mov_b32 s13, s63
s_mov_b32 s14, 3407872
s_mov_b32 s15, 0x00020000
s_load_dword s16, s[12:13], 0
s_mov_b64 s[26:27], s[58:59]
s_mov_b64 s[20:21], s[54:55]
v_and_b32 v13, 1, v1
v_cmp_eq_u32 vcc, 1, v13
v_mov_b32 v14, 0x0c0c0100
v_mov_b32 v15, 0x01000c0c
v_cndmask_b32 v14, v14, v15, vcc
v_mov_b32 v31, 0x0c0c0302
v_mov_b32 v15, 0x03020c0c
v_cndmask_b32 v15, v31, v15, vcc
v_bfe_u32 v13, v1, 1, 2
v_mov_b32 v31, 0x0c0c0c0c
v_cmp_eq_u32 vcc, 0, v13
s_nop 1
v_cndmask_b32 v4, v31, v14, vcc
v_cndmask_b32 v8, v31, v15, vcc
v_cmp_eq_u32 vcc, 1, v13
s_nop 1
v_cndmask_b32 v5, v31, v14, vcc
v_cndmask_b32 v9, v31, v15, vcc
v_cmp_eq_u32 vcc, 2, v13
s_nop 1
v_cndmask_b32 v6, v31, v14, vcc
v_cndmask_b32 v10, v31, v15, vcc
v_cmp_eq_u32 vcc, 3, v13
s_nop 1
v_cndmask_b32 v7, v31, v14, vcc
v_cndmask_b32 v11, v31, v15, vcc
v_mov_b32 v16, 0x07060302
v_mov_b32 v17, 0xfffefffe
v_mov_b32 v19, 0xffffff00
v_lshrrev_b32 v22, 5, v1
v_lshlrev_b32 v22, 8, v22
v_and_b32 v23, 7, v1
v_lshl_add_u32 v22, v23, 4, v22
v_bfe_u32 v23, v1, 3, 2
v_lshl_add_u32 v22, v23, 2, v22
v_add_u32 v18, 131072, v22
s_waitcnt vmcnt(14)
v_perm_b32 v128, v24, v24, v4
v_perm_b32 v129, v24, v24, v5
v_perm_b32 v130, v24, v24, v6
v_perm_b32 v131, v24, v24, v7
v_perm_b32 v132, v24, v24, v8
v_perm_b32 v133, v24, v24, v9
v_perm_b32 v134, v24, v24, v10
v_perm_b32 v135, v24, v24, v11
v_perm_b32 v136, v25, v25, v4
v_perm_b32 v137, v25, v25, v5
v_perm_b32 v138, v25, v25, v6
v_perm_b32 v139, v25, v25, v7
v_perm_b32 v140, v25, v25, v8
v_perm_b32 v141, v25, v25, v9
v_perm_b32 v142, v25, v25, v10
v_perm_b32 v143, v25, v25, v11
v_perm_b32 v144, v26, v26, v4
v_perm_b32 v145, v26, v26, v5
v_perm_b32 v146, v26, v26, v6
v_perm_b32 v147, v26, v26, v7
v_perm_b32 v148, v26, v26, v8
v_perm_b32 v149, v26, v26, v9
v_perm_b32 v150, v26, v26, v10
v_perm_b32 v151, v26, v26, v11
v_perm_b32 v152, v27, v27, v4
v_perm_b32 v153, v27, v27, v5
v_perm_b32 v154, v27, v27, v6
v_perm_b32 v155, v27, v27, v7
v_perm_b32 v156, v27, v27, v8
v_perm_b32 v157, v27, v27, v9
v_perm_b32 v158, v27, v27, v10
v_perm_b32 v159, v27, v27, v11
v_perm_b32 v160, v28, v28, v4
v_perm_b32 v161, v28, v28, v5
v_perm_b32 v162, v28, v28, v6
v_perm_b32 v163, v28, v28, v7
v_perm_b32 v164, v28, v28, v8
v_perm_b32 v165, v28, v28, v9
v_perm_b32 v166, v28, v28, v10
v_perm_b32 v167, v28, v28, v11
v_perm_b32 v168, v29, v29, v4
v_perm_b32 v169, v29, v29, v5
v_perm_b32 v170, v29, v29, v6
v_perm_b32 v171, v29, v29, v7
v_perm_b32 v172, v29, v29, v8
v_perm_b32 v173, v29, v29, v9
v_perm_b32 v174, v29, v29, v10
v_perm_b32 v175, v29, v29, v11
v_perm_b32 v176, v30, v30, v4
v_perm_b32 v177, v30, v30, v5
v_perm_b32 v178, v30, v30, v6
v_perm_b32 v179, v30, v30, v7
v_perm_b32 v180, v30, v30, v8
v_perm_b32 v181, v30, v30, v9
v_perm_b32 v182, v30, v30, v10
v_perm_b32 v183, v30, v30, v11
s_waitcnt lgkmcnt(0)
s_add_u32 s16, s16, 0x01010101
s_and_b32 s17, s16, 0xff
s_bfe_u32 s18, s16, 0x80010
s_lshl_b32 s28, s3, 10
s_add_u32 s28, s28, 131072
v_lshl_add_u32 v31, v1, 4, s28
v_and_b32 v95, 1, v1
v_lshlrev_b32 v95, 4, v95
v_lshrrev_b32 v95, v95, s16
v_and_b32 v95, 0xffff, v95
v_mov_b32 v29, 0xffff0000
v_lshlrev_b32 v30, 2, v1
s_and_b32 s28, s2, 64
s_add_u32 s28, s28, s35
s_lshl_b32 s28, s28, 8
s_add_u32 s28, s28, 131072
s_add_u32 s29, s28, 0x8000
s_waitcnt vmcnt(13)
v_mfma_f32_16x16x32_bf16 v[96:99], v[192:195], v[128:131], 0
s_waitcnt vmcnt(12)
v_mfma_f32_16x16x32_bf16 v[96:99], v[196:199], v[132:135], v[96:99]
s_waitcnt vmcnt(11)
v_mfma_f32_16x16x32_bf16 v[96:99], v[200:203], v[136:139], v[96:99]
s_waitcnt vmcnt(10)
v_mfma_f32_16x16x32_bf16 v[96:99], v[204:207], v[140:143], v[96:99]
s_waitcnt vmcnt(9)
v_mfma_f32_16x16x32_bf16 v[96:99], v[208:211], v[144:147], v[96:99]
s_waitcnt vmcnt(8)
v_mfma_f32_16x16x32_bf16 v[96:99], v[212:215], v[148:151], v[96:99]
s_waitcnt vmcnt(7)
v_mfma_f32_16x16x32_bf16 v[96:99], v[216:219], v[152:155], v[96:99]
s_waitcnt vmcnt(6)
v_mfma_f32_16x16x32_bf16 v[96:99], v[220:223], v[156:159], v[96:99]
s_waitcnt vmcnt(5)
v_mfma_f32_16x16x32_bf16 v[96:99], v[224:227], v[160:163], v[96:99]
s_waitcnt vmcnt(4)
v_mfma_f32_16x16x32_bf16 v[96:99], v[228:231], v[164:167], v[96:99]
s_waitcnt vmcnt(3)
v_mfma_f32_16x16x32_bf16 v[96:99], v[232:235], v[168:171], v[96:99]
s_waitcnt vmcnt(2)
v_mfma_f32_16x16x32_bf16 v[96:99], v[236:239], v[172:175], v[96:99]
s_waitcnt vmcnt(1)
v_mfma_f32_16x16x32_bf16 v[96:99], v[240:243], v[176:179], v[96:99]
s_waitcnt vmcnt(0)
v_mfma_f32_16x16x32_bf16 v[96:99], v[244:247], v[180:183], v[96:99]
s_nop 7
ds_write_b128 v31, v[96:99]
s_waitcnt lgkmcnt(0)
s_barrier
s_cmp_lg_u32 s3, 0
s_cbranch_scc1 C_P1done
ds_read_b32 v20, v18 offset:0
ds_read_b32 v21, v18 offset:640
ds_read_b32 v22, v18 offset:1024
ds_read_b32 v23, v18 offset:1664
ds_read_b32 v24, v18 offset:2048
ds_read_b32 v25, v18 offset:2688
ds_read_b32 v26, v18 offset:3072
ds_read_b32 v27, v18 offset:3712
s_waitcnt lgkmcnt(0)
v_add_f32 v20, v20, v21
v_add_f32 v22, v22, v23
v_add_f32 v24, v24, v25
v_add_f32 v26, v26, v27
v_add_f32 v20, v20, v22
v_add_f32 v24, v24, v26
v_add_f32 v20, v20, v24
v_cvt_pk_bf16_f32 v20, v20, v20
v_and_or_b32 v20, v20, v29, v95
buffer_store_dword v20, v30, s[12:15], s28 offen sc1
s_cmp_ge_u32 s2, 64
s_cbranch_scc1 C_P1done
buffer_store_dword v20, v30, s[12:15], s29 offen sc1
C_P1done:
s_branch C_join
C_A:
v_mov_b32 v12, 0
v_mov_b32 v2, 163072
v_mov_b32 v3, 1
s_bfe_u32 s101, s2, 0x20003
s_and_b32 s28, s2, 7
s_and_b32 s31, s2, 0xc0
s_lshl_b32 s28, s28, 3
s_add_u32 s31, s31, s28
s_bfe_u32 s28, s2, 0x30003
s_add_u32 s31, s31, s28
v_mov_b32 v0, s31
s_setprio 3
s_sub_u32 s3, s3, 4
s_waitcnt lgkmcnt(0)
s_mov_b32 s12, s62
s_mov_b32 s13, s63
s_mov_b32 s14, 3407872
s_mov_b32 s15, 0x00020000
s_load_dword s16, s[12:13], 0
s_mov_b64 s[26:27], s[58:59]
s_mov_b64 s[20:21], s[54:55]
v_and_b32 v13, 1, v1
v_cmp_eq_u32 vcc, 1, v13
v_mov_b32 v14, 0x0c0c0100
v_mov_b32 v15, 0x01000c0c
v_cndmask_b32 v14, v14, v15, vcc
v_mov_b32 v31, 0x0c0c0302
v_mov_b32 v15, 0x03020c0c
v_cndmask_b32 v15, v31, v15, vcc
v_bfe_u32 v13, v1, 1, 2
v_mov_b32 v31, 0x0c0c0c0c
v_cmp_eq_u32 vcc, 0, v13
s_nop 1
v_cndmask_b32 v4, v31, v14, vcc
v_cndmask_b32 v8, v31, v15, vcc
v_cmp_eq_u32 vcc, 1, v13
s_nop 1
v_cndmask_b32 v5, v31, v14, vcc
v_cndmask_b32 v9, v31, v15, vcc
v_cmp_eq_u32 vcc, 2, v13
s_nop 1
v_cndmask_b32 v6, v31, v14, vcc
v_cndmask_b32 v10, v31, v15, vcc
v_cmp_eq_u32 vcc, 3, v13
s_nop 1
v_cndmask_b32 v7, v31, v14, vcc
v_cndmask_b32 v11, v31, v15, vcc
v_mov_b32 v16, 0x07060302
v_mov_b32 v17, 0xfffefffe
v_mov_b32 v19, 0xffffff00
s_waitcnt vmcnt(3)
v_xor_b32 v21, 128, v20
s_add_u32 m0, s35, 4096
s_nop 0
buffer_load_dwordx4 v21, s[4:7], s34 offen nt lds
s_add_u32 s34, s34, 16384
s_waitcnt vmcnt(3)
v_xor_b32 v21, 160, v20
s_add_u32 m0, s35, 5120
s_nop 0
buffer_load_dwordx4 v21, s[4:7], s34 offen nt lds
s_add_u32 s34, s34, 16384
s_waitcnt vmcnt(3)
v_xor_b32 v21, 192, v20
s_add_u32 m0, s35, 6144
s_nop 0
buffer_load_dwordx4 v21, s[4:7], s34 offen nt lds
s_add_u32 s34, s34, 16384
s_waitcnt vmcnt(3)
v_xor_b32 v21, 224, v20
s_add_u32 m0, s35, 7168
s_nop 0
buffer_load_dwordx4 v21, s[4:7], s34 offen nt lds
s_add_u32 s34, s34, 16384
s_waitcnt vmcnt(3)
v_xor_b32 v21, 0, v20
s_add_u32 m0, s35, 8192
s_nop 0
buffer_load_dwordx4 v21, s[4:7], s34 offen nt lds
s_add_u32 s34, s34, 16384
s_waitcnt vmcnt(3)
v_xor_b32 v21, 32, v20
s_add_u32 m0, s35, 9216
s_nop 0
buffer_load_dwordx4 v21, s[4:7], s34 offen nt lds
s_add_u32 s34, s34, 16384
s_waitcnt vmcnt(3)
v_xor_b32 v21, 64, v20
s_add_u32 m0, s35, 10240
s_nop 0
buffer_load_dwordx4 v21, s[4:7], s34 offen nt lds
s_add_u32 s34, s34, 16384
s_waitcnt vmcnt(3)
v_xor_b32 v21, 96, v20
s_add_u32 m0, s35, 11264
s_nop 0
buffer_load_dwordx4 v21, s[4:7], s34 offen nt lds
s_add_u32 s34, s34, 16384
s_waitcnt vmcnt(3)
v_xor_b32 v21, 128, v20
s_add_u32 m0, s35, 12288
s_nop 0
buffer_load_dwordx4 v21, s[4:7], s34 offen nt lds
s_add_u32 s34, s34, 16384
s_waitcnt vmcnt(3)
v_xor_b32 v21, 160, v20
s_add_u32 m0, s35, 13312
s_nop 0
buffer_load_dwordx4 v21, s[4:7], s34 offen nt lds
s_add_u32 s34, s34, 16384
s_waitcnt vmcnt(3)
v_xor_b32 v21, 192, v20
s_add_u32 m0, s35, 14336
s_nop 0
buffer_load_dwordx4 v21, s[4:7], s34 offen nt lds
s_add_u32 s34, s34, 16384
s_waitcnt vmcnt(3)
v_xor_b32 v21, 224, v20
s_add_u32 m0, s35, 15360
s_nop 0
buffer_load_dwordx4 v21, s[4:7], s34 offen nt lds
s_waitcnt lgkmcnt(0)
s_add_u32 s16, s16, 0x01010101
s_and_b32 s17, s16, 0xff
s_bfe_u32 s18, s16, 0x80010
s_lshl_b32 s28, s3, 10
s_add_u32 s28, s28, 139776
v_add_u32 v24, s28, v1
v_and_b32 v20, 15, v1
v_lshrrev_b32 v21, 4, v1
v_xor_b32 v21, v21, v20
s_and_b32 s28, s3, 1
s_lshl_b32 s28, s28, 3
v_xor_b32 v21, s28, v21
v_lshlrev_b32 v21, 4, v21
v_lshl_add_u32 v21, v20, 9, v21
s_lshr_b32 s28, s3, 1
s_lshl_b32 s28, s28, 8
s_add_u32 s28, s28, 0x10000
v_add_u32 v25, s28, v21
v_xor_b32 v26, 64, v25
s_bfe_u32 s34, s2, 0x40002
s_lshl_b32 s34, s34, 2
s_add_u32 s34, s34, s3
s_lshl_b32 s34, s34, 8
s_add_u32 s34, s34, 0x8000
v_lshrrev_b32 v22, 5, v1
v_lshlrev_b32 v22, 8, v22
v_and_b32 v23, 7, v1
v_lshl_add_u32 v22, v23, 4, v22
v_bfe_u32 v23, v1, 3, 2
v_lshl_add_u32 v22, v23, 2, v22
v_add_u32 v18, 131072, v22
v_lshlrev_b32 v96, 4, v1
v_add_u32 v96, 139264, v96
v_lshrrev_b32 v97, 4, v1
v_lshlrev_b32 v97, 11, v97
v_bfe_u32 v98, v1, 1, 1
v_lshl_add_u32 v97, v98, 10, v97
v_bfe_u32 v98, v1, 2, 2
v_lshl_add_u32 v97, v98, 4, v97
v_and_b32 v98, 1, v1
v_lshl_add_u32 v97, v98, 3, v97
v_bfe_u32 v102, v97, 1, 5
v_lshrrev_b32 v102, v102, s16
v_bfe_u32 v103, v102, 1, 1
v_bfe_u32 v100, v102, 0, 1
v_lshl_or_b32 v100, v103, 16, v100
v_bfe_u32 v103, v102, 3, 1
v_bfe_u32 v101, v102, 2, 1
v_lshl_or_b32 v101, v103, 16, v101
v_lshlrev_b32 v98, 8, v1
v_mov_b32 v99, s16
s_and_b32 s24, s2, 3
s_lshl_b32 s24, s24, 13
s_bfe_u32 s29, s2, 0x40002
s_lshl_b32 s29, s29, 6
s_add_u32 s24, s24, s29
s_add_u32 s24, s24, 262144
s_and_b32 s28, s2, 3
s_lshl_b32 s28, s28, 6
s_bfe_u32 s29, s2, 0x40002
s_lshl_b32 s29, s29, 2
s_add_u32 s28, s28, s29
s_add_u32 s25, s28, 294912
s_lshr_b32 s35, s16, 16
s_mov_b32 s33, 25000
SP_3:
s_load_dwordx16 s[36:51], s[12:13], s34 offset:131072 glc
s_load_dwordx16 s[52:67], s[12:13], s34 offset:131136 glc
s_load_dwordx16 s[68:83], s[12:13], s34 offset:131200 glc
s_load_dwordx16 s[84:99], s[12:13], s34 offset:131264 glc
s_sub_u32 s33, s33, 1
s_cbranch_scc1 SE_4
s_waitcnt lgkmcnt(0)
s_and_b64 s[28:29], s[36:37], s[38:39]
s_or_b64 s[30:31], s[36:37], s[38:39]
s_and_b64 s[28:29], s[28:29], s[40:41]
s_or_b64 s[30:31], s[30:31], s[40:41]
s_and_b64 s[28:29], s[28:29], s[42:43]
s_or_b64 s[30:31], s[30:31], s[42:43]
s_and_b64 s[28:29], s[28:29], s[44:45]
s_or_b64 s[30:31], s[30:31], s[44:45]
s_and_b64 s[28:29], s[28:29], s[46:47]
s_or_b64 s[30:31], s[30:31], s[46:47]
s_and_b64 s[28:29], s[28:29], s[48:49]
s_or_b64 s[30:31], s[30:31], s[48:49]
s_and_b64 s[28:29], s[28:29], s[50:51]
s_or_b64 s[30:31], s[30:31], s[50:51]
s_and_b64 s[28:29], s[28:29], s[52:53]
s_or_b64 s[30:31], s[30:31], s[52:53]
s_and_b64 s[28:29], s[28:29], s[54:55]
s_or_b64 s[30:31], s[30:31], s[54:55]
s_and_b64 s[28:29], s[28:29], s[56:57]
s_or_b64 s[30:31], s[30:31], s[56:57]
s_and_b64 s[28:29], s[28:29], s[58:59]
s_or_b64 s[30:31], s[30:31], s[58:59]
s_and_b64 s[28:29], s[28:29], s[60:61]
s_or_b64 s[30:31], s[30:31], s[60:61]
s_and_b64 s[28:29], s[28:29], s[62:63]
s_or_b64 s[30:31], s[30:31], s[62:63]
s_and_b64 s[28:29], s[28:29], s[64:65]
s_or_b64 s[30:31], s[30:31], s[64:65]
s_and_b64 s[28:29], s[28:29], s[66:67]
s_or_b64 s[30:31], s[30:31], s[66:67]
s_and_b64 s[28:29], s[28:29], s[68:69]
s_or_b64 s[30:31], s[30:31], s[68:69]
s_and_b64 s[28:29], s[28:29], s[70:71]
s_or_b64 s[30:31], s[30:31], s[70:71]
s_and_b64 s[28:29], s[28:29], s[72:73]
s_or_b64 s[30:31], s[30:31], s[72:73]
s_and_b64 s[28:29], s[28:29], s[74:75]
s_or_b64 s[30:31], s[30:31], s[74:75]
s_and_b64 s[28:29], s[28:29], s[76:77]
s_or_b64 s[30:31], s[30:31], s[76:77]
s_and_b64 s[28:29], s[28:29], s[78:79]
s_or_b64 s[30:31], s[30:31], s[78:79]
s_and_b64 s[28:29], s[28:29], s[80:81]
s_or_b64 s[30:31], s[30:31], s[80:81]
s_and_b64 s[28:29], s[28:29], s[82:83]
s_or_b64 s[30:31], s[30:31], s[82:83]
s_and_b64 s[28:29], s[28:29], s[84:85]
s_or_b64 s[30:31], s[30:31], s[84:85]
s_and_b64 s[28:29], s[28:29], s[86:87]
s_or_b64 s[30:31], s[30:31], s[86:87]
s_and_b64 s[28:29], s[28:29], s[88:89]
s_or_b64 s[30:31], s[30:31], s[88:89]
s_and_b64 s[28:29], s[28:29], s[90:91]
s_or_b64 s[30:31], s[30:31], s[90:91]
s_and_b64 s[28:29], s[28:29], s[92:93]
s_or_b64 s[30:31], s[30:31], s[92:93]
s_and_b64 s[28:29], s[28:29], s[94:95]
s_or_b64 s[30:31], s[30:31], s[94:95]
s_and_b64 s[28:29], s[28:29], s[96:97]
s_or_b64 s[30:31], s[30:31], s[96:97]
s_and_b64 s[28:29], s[28:29], s[98:99]
s_or_b64 s[30:31], s[30:31], s[98:99]
s_xor_b32 s28, s28, s16
s_xor_b32 s29, s29, s35
s_xor_b32 s30, s30, s16
s_xor_b32 s31, s31, s35
s_or_b64 s[28:29], s[28:29], s[30:31]
s_or_b32 s28, s28, s29
s_and_b32 s28, s28, 0xffff
s_cbranch_scc1 SP_3
SE_4:
s_waitcnt lgkmcnt(0)
s_pack_hh_b32_b16 s36, s36, s37
s_pack_hh_b32_b16 s37, s38, s39
s_pack_hh_b32_b16 s38, s40, s41
s_pack_hh_b32_b16 s39, s42, s43
s_pack_hh_b32_b16 s40, s44, s45
s_pack_hh_b32_b16 s41, s46, s47
s_pack_hh_b32_b16 s42, s48, s49
s_pack_hh_b32_b16 s43, s50, s51
s_pack_hh_b32_b16 s44, s52, s53
s_pack_hh_b32_b16 s45, s54, s55
s_pack_hh_b32_b16 s46, s56, s57
s_pack_hh_b32_b16 s47, s58, s59
s_pack_hh_b32_b16 s48, s60, s61
s_pack_hh_b32_b16 s49, s62, s63
s_pack_hh_b32_b16 s50, s64, s65
s_pack_hh_b32_b16 s51, s66, s67
s_pack_hh_b32_b16 s52, s68, s69
s_pack_hh_b32_b16 s53, s70, s71
s_pack_hh_b32_b16 s54, s72, s73
s_pack_hh_b32_b16 s55, s74, s75
s_pack_hh_b32_b16 s56, s76, s77
s_pack_hh_b32_b16 s57, s78, s79
s_pack_hh_b32_b16 s58, s80, s81
s_pack_hh_b32_b16 s59, s82, s83
s_pack_hh_b32_b16 s60, s84, s85
s_pack_hh_b32_b16 s61, s86, s87
s_pack_hh_b32_b16 s62, s88, s89
s_pack_hh_b32_b16 s63, s90, s91
s_pack_hh_b32_b16 s64, s92, s93
s_pack_hh_b32_b16 s65, s94, s95
s_pack_hh_b32_b16 s66, s96, s97
s_pack_hh_b32_b16 s67, s98, s99
s_mov_b32 exec_lo, 0xffff
s_mov_b32 exec_hi, 0x0
v_mov_b32 v32, s36
v_mov_b32 v33, s37
v_mov_b32 v34, s38
v_mov_b32 v35, s39
v_mov_b32 v36, s52
v_mov_b32 v37, s53
v_mov_b32 v38, s54
v_mov_b32 v39, s55
s_mov_b32 exec_lo, 0xffff0000
s_mov_b32 exec_hi, 0x0
v_mov_b32 v32, s40
v_mov_b32 v33, s41
v_mov_b32 v34, s42
v_mov_b32 v35, s43
v_mov_b32 v36, s56
v_mov_b32 v37, s57
v_mov_b32 v38, s58
v_mov_b32 v39, s59
s_mov_b32 exec_lo, 0x0
s_mov_b32 exec_hi, 0xffff
v_mov_b32 v32, s44
v_mov_b32 v33, s45
v_mov_b32 v34, s46
v_mov_b32 v35, s47
v_mov_b32 v36, s60
v_mov_b32 v37, s61
v_mov_b32 v38, s62
v_mov_b32 v39, s63
s_mov_b32 exec_lo, 0x0
s_mov_b32 exec_hi, 0xffff0000
v_mov_b32 v32, s48
v_mov_b32 v33, s49
v_mov_b32 v34, s50
v_mov_b32 v35, s51
v_mov_b32 v36, s64
v_mov_b32 v37, s65
v_mov_b32 v38, s66
v_mov_b32 v39, s67
s_mov_b64 exec, -1
s_waitcnt vmcnt(0)
s_barrier
ds_read_b128 v[128:131], v25 offset:0
ds_read_b128 v[132:135], v26 offset:0
ds_read_b128 v[136:139], v25 offset:8192
ds_read_b128 v[140:143], v26 offset:8192
ds_read_b128 v[144:147], v25 offset:16384
ds_read_b128 v[148:151], v26 offset:16384
ds_read_b128 v[152:155], v25 offset:24576
ds_read_b128 v[156:159], v26 offset:24576
ds_read_b128 v[160:163], v25 offset:32768
ds_read_b128 v[164:167], v26 offset:32768
ds_read_b128 v[168:171], v25 offset:40960
ds_read_b128 v[172:175], v26 offset:40960
ds_read_b128 v[176:179], v25 offset:49152
ds_read_b128 v[180:183], v26 offset:49152
ds_read_b128 v[184:187], v25 offset:57344
ds_read_b128 v[188:191], v26 offset:57344
s_waitcnt lgkmcnt(14)
v_mfma_f32_16x16x32_bf16 v[40:43], v[128:131], v[32:35], 0
v_mfma_f32_16x16x32_bf16 v[40:43], v[132:135], v[36:39], v[40:43]
s_waitcnt lgkmcnt(12)
v_mfma_f32_16x16x32_bf16 v[44:47], v[136:139], v[32:35], 0
v_mfma_f32_16x16x32_bf16 v[44:47], v[140:143], v[36:39], v[44:47]
s_waitcnt lgkmcnt(10)
v_mfma_f32_16x16x32_bf16 v[48:51], v[144:147], v[32:35], 0
v_mfma_f32_16x16x32_bf16 v[48:51], v[148:151], v[36:39], v[48:51]
s_waitcnt lgkmcnt(8)
v_mfma_f32_16x16x32_bf16 v[52:55], v[152:155], v[32:35], 0
v_mfma_f32_16x16x32_bf16 v[52:55], v[156:159], v[36:39], v[52:55]
s_waitcnt lgkmcnt(6)
v_mfma_f32_16x16x32_bf16 v[56:59], v[160:163], v[32:35], 0
v_mfma_f32_16x16x32_bf16 v[56:59], v[164:167], v[36:39], v[56:59]
s_waitcnt lgkmcnt(4)
v_mfma_f32_16x16x32_bf16 v[60:63], v[168:171], v[32:35], 0
v_mfma_f32_16x16x32_bf16 v[60:63], v[172:175], v[36:39], v[60:63]
s_waitcnt lgkmcnt(2)
v_mfma_f32_16x16x32_bf16 v[64:67], v[176:179], v[32:35], 0
v_mfma_f32_16x16x32_bf16 v[64:67], v[180:183], v[36:39], v[64:67]
s_waitcnt lgkmcnt(0)
v_mfma_f32_16x16x32_bf16 v[68:71], v[184:187], v[32:35], 0
v_mfma_f32_16x16x32_bf16 v[68:71], v[188:191], v[36:39], v[68:71]
s_mov_b32 exec_lo, 0x00010001
s_mov_b32 exec_hi, 0x00010001
ds_write_b128 v24, v[40:43] offset:0
ds_write_b128 v24, v[44:47] offset:64
ds_write_b128 v24, v[48:51] offset:128
ds_write_b128 v24, v[52:55] offset:192
ds_write_b128 v24, v[56:59] offset:256
ds_write_b128 v24, v[60:63] offset:320
ds_write_b128 v24, v[64:67] offset:384
ds_write_b128 v24, v[68:71] offset:448
s_mov_b64 exec, -1
s_sub_u32 s29, s24, 65536
s_waitcnt lgkmcnt(0)
s_barrier
s_cmp_lg_u32 s3, 0
s_cbranch_scc1 C_P2done
ds_read_b128 v[32:35], v96 offset:0
ds_read_b128 v[36:39], v96 offset:1024
ds_read_b128 v[40:43], v96 offset:2048
ds_read_b128 v[44:47], v96 offset:3072
s_waitcnt lgkmcnt(0)
v_add_f32 v32, v32, v36
v_add_f32 v40, v40, v44
v_add_f32 v33, v33, v37
v_add_f32 v41, v41, v45
v_add_f32 v34, v34, v38
v_add_f32 v42, v42, v46
v_add_f32 v35, v35, v39
v_add_f32 v43, v43, v47
v_add_f32 v32, v32, v40
v_add_f32 v33, v33, v41
v_add_f32 v34, v34, v42
v_add_f32 v35, v35, v43
v_perm_b32 v22, v33, v32, v16
v_add_u32 v22, 0x00010001, v22
v_and_or_b32 v22, v22, v17, v100
v_perm_b32 v23, v35, v34, v16
v_add_u32 v23, 0x00010001, v23
v_and_or_b32 v23, v23, v17, v101
buffer_store_dwordx2 v[22:23], v97, s[12:15], s24 offen sc1
v_and_b32 v26, v17, v22
v_lshlrev_b32 v36, 16, v26
v_and_b32 v37, 0xffff0000, v26
v_and_b32 v27, v17, v23
v_lshlrev_b32 v38, 16, v27
v_and_b32 v39, 0xffff0000, v27
v_sub_f32 v32, v32, v36
v_sub_f32 v33, v33, v37
v_sub_f32 v34, v34, v38
v_sub_f32 v35, v35, v39
v_perm_b32 v24, v33, v32, v16
v_add_u32 v24, 0x00010001, v24
v_and_or_b32 v24, v24, v17, v100
v_perm_b32 v25, v35, v34, v16
v_add_u32 v25, 0x00010001, v25
v_and_or_b32 v25, v25, v17, v101
buffer_store_dwordx2 v[24:25], v97, s[12:15], s29 offen sc1
s_mov_b64 exec, 0xff
buffer_store_dword v99, v98, s[12:15], s25 offen sc1
s_mov_b64 exec, -1
C_P2done:
s_branch C_join
C_B:
v_mov_b32 v12, 0
v_mov_b32 v2, 163072
v_mov_b32 v3, 1
s_bfe_u32 s101, s2, 0x20003
s_and_b32 s28, s2, 7
s_and_b32 s31, s2, 0xc0
s_lshl_b32 s28, s28, 3
s_add_u32 s31, s31, s28
s_bfe_u32 s28, s2, 0x30003
s_add_u32 s31, s31, s28
v_mov_b32 v0, s31
s_setprio 3
s_sub_u32 s3, s3, 4
s_waitcnt lgkmcnt(0)
s_mov_b32 s12, s62
s_mov_b32 s13, s63
s_mov_b32 s14, 3407872
s_mov_b32 s15, 0x00020000
s_load_dword s16, s[12:13], 0
s_mov_b64 s[26:27], s[58:59]
s_mov_b64 s[20:21], s[54:55]
s_sub_u32 s28, s2, 192
s_lshl_b32 s28, s28, 18
s_lshl_b32 s65, s3, 14
s_add_u32 s64, s28, s65
s_and_b32 s28, s3, 1
s_lshl_b32 s28, s28, 4
v_lshlrev_b32 v110, 4, v1
v_xor_b32 v110, s28, v110
s_mov_b32 s4, s48
s_mov_b32 s5, s49
s_mov_b32 s6, 16777216
s_mov_b32 s7, 0x00020000
s_barrier
v_and_b32 v13, 1, v1
v_cmp_eq_u32 vcc, 1, v13
v_mov_b32 v14, 0x0c0c0100
v_mov_b32 v15, 0x01000c0c
v_cndmask_b32 v14, v14, v15, vcc
v_mov_b32 v31, 0x0c0c0302
v_mov_b32 v15, 0x03020c0c
v_cndmask_b32 v15, v31, v15, vcc
v_bfe_u32 v13, v1, 1, 2
v_mov_b32 v31, 0x0c0c0c0c
v_cmp_eq_u32 vcc, 0, v13
s_nop 1
v_cndmask_b32 v4, v31, v14, vcc
v_cndmask_b32 v8, v31, v15, vcc
v_cmp_eq_u32 vcc, 1, v13
s_nop 1
v_cndmask_b32 v5, v31, v14, vcc
v_cndmask_b32 v9, v31, v15, vcc
v_cmp_eq_u32 vcc, 2, v13
s_nop 1
v_cndmask_b32 v6, v31, v14, vcc
v_cndmask_b32 v10, v31, v15, vcc
v_cmp_eq_u32 vcc, 3, v13
s_nop 1
v_cndmask_b32 v7, v31, v14, vcc
v_cndmask_b32 v11, v31, v15, vcc
v_mov_b32 v16, 0x07060302
v_mov_b32 v17, 0xfffefffe
v_mov_b32 v19, 0xffffff00
v_lshrrev_b32 v22, 5, v1
v_lshlrev_b32 v22, 8, v22
v_and_b32 v23, 7, v1
v_lshl_add_u32 v22, v23, 4, v22
v_bfe_u32 v23, v1, 3, 2
v_lshl_add_u32 v22, v23, 2, v22
v_add_u32 v18, 131072, v22
s_lshl_b32 s34, s3, 9
v_lshrrev_b32 v20, 2, v1
v_and_b32 v21, 7, v20
v_lshlrev_b32 v21, 1, v21
v_lshrrev_b32 v22, 3, v20
v_or_b32 v21, v21, v22
v_bfe_u32 v22, v1, 1, 1
v_xor_b32 v21, v21, v22
v_lshlrev_b32 v21, 4, v21
v_and_b32 v22, 1, v1
v_lshl_add_u32 v21, v22, 3, v21
v_lshl_add_u32 v21, v20, 11, v21
v_add_u32 v21, s34, v21
v_xor_b32 v120, 0, v21
v_xor_b32 v121, 32, v21
v_xor_b32 v122, 64, v21
v_xor_b32 v123, 96, v21
v_xor_b32 v124, 128, v21
v_xor_b32 v125, 160, v21
v_xor_b32 v126, 192, v21
v_xor_b32 v127, 224, v21
s_waitcnt lgkmcnt(0)
s_add_u32 s16, s16, 0x01010101
s_and_b32 s17, s16, 0xff
s_bfe_u32 s18, s16, 0x80010
s_mov_b32 s33, 200000
LW_5:
ds_read_b32 v13, v2 offset:8
s_sub_u32 s33, s33, 1
s_cbranch_scc1 LE_6
s_waitcnt lgkmcnt(0)
v_readfirstlane_b32 s32, v13
s_nop 0
s_cmp_ge_u32 s32, 4
s_cbranch_scc1 LE_6
s_sleep 1
s_branch LW_5
LE_6:
s_waitcnt lgkmcnt(0)
ds_read_b64_tr_b16 v[128:129], v120 offset:0
ds_read_b64_tr_b16 v[130:131], v120 offset:32768
ds_read_b64_tr_b16 v[136:137], v121 offset:0
ds_read_b64_tr_b16 v[138:139], v121 offset:32768
ds_read_b64_tr_b16 v[144:145], v122 offset:0
ds_read_b64_tr_b16 v[146:147], v122 offset:32768
ds_read_b64_tr_b16 v[152:153], v123 offset:0
ds_read_b64_tr_b16 v[154:155], v123 offset:32768
ds_read_b64_tr_b16 v[160:161], v124 offset:0
ds_read_b64_tr_b16 v[162:163], v124 offset:32768
ds_read_b64_tr_b16 v[168:169], v125 offset:0
ds_read_b64_tr_b16 v[170:171], v125 offset:32768
ds_read_b64_tr_b16 v[176:177], v126 offset:0
ds_read_b64_tr_b16 v[178:179], v126 offset:32768
ds_read_b64_tr_b16 v[184:185], v127 offset:0
ds_read_b64_tr_b16 v[186:187], v127 offset:32768
ds_read_b64_tr_b16 v[192:193], v120 offset:256
ds_read_b64_tr_b16 v[194:195], v120 offset:33024
ds_read_b64_tr_b16 v[200:201], v121 offset:256
ds_read_b64_tr_b16 v[202:203], v121 offset:33024
ds_read_b64_tr_b16 v[208:209], v122 offset:256
ds_read_b64_tr_b16 v[210:211], v122 offset:33024
ds_read_b64_tr_b16 v[216:217], v123 offset:256
ds_read_b64_tr_b16 v[218:219], v123 offset:33024
ds_read_b64_tr_b16 v[224:225], v124 offset:256
ds_read_b64_tr_b16 v[226:227], v124 offset:33024
ds_read_b64_tr_b16 v[232:233], v125 offset:256
ds_read_b64_tr_b16 v[234:235], v125 offset:33024
ds_read_b64_tr_b16 v[240:241], v126 offset:256
ds_read_b64_tr_b16 v[242:243], v126 offset:33024
ds_read_b64_tr_b16 v[248:249], v127 offset:256
ds_read_b64_tr_b16 v[250:251], v127 offset:33024
s_waitcnt lgkmcnt(0)
s_mov_b64 exec, 1
ds_add_u32 v2, v3 offset:24
s_mov_b64 exec, -1
s_mov_b32 s33, 200000
LW_7:
ds_read_b32 v13, v2 offset:24
s_sub_u32 s33, s33, 1
s_cbranch_scc1 LE_8
s_waitcnt lgkmcnt(0)
v_readfirstlane_b32 s32, v13
s_nop 0
s_cmp_ge_u32 s32, 8
s_cbranch_scc0 LW_7
LE_8:
s_waitcnt lgkmcnt(0)
v_xor_b32 v23, 0, v110
s_add_u32 m0, s65, 0
s_add_u32 s28, s64, 131072
buffer_load_dwordx4 v23, s[4:7], s28 offen offset:0 nt lds
buffer_load_dwordx4 v23, s[4:7], s28 offen offset:1024 nt lds
v_xor_b32 v23, 32, v110
s_add_u32 m0, s65, 2048
s_add_u32 s28, s64, 133120
buffer_load_dwordx4 v23, s[4:7], s28 offen offset:0 nt lds
buffer_load_dwordx4 v23, s[4:7], s28 offen offset:1024 nt lds
v_xor_b32 v23, 64, v110
s_add_u32 m0, s65, 4096
s_add_u32 s28, s64, 135168
buffer_load_dwordx4 v23, s[4:7], s28 offen offset:0 nt lds
buffer_load_dwordx4 v23, s[4:7], s28 offen offset:1024 nt lds
v_xor_b32 v23, 96, v110
s_add_u32 m0, s65, 6144
s_add_u32 s28, s64, 137216
buffer_load_dwordx4 v23, s[4:7], s28 offen offset:0 nt lds
buffer_load_dwordx4 v23, s[4:7], s28 offen offset:1024 nt lds
v_xor_b32 v23, 128, v110
s_add_u32 m0, s65, 8192
s_add_u32 s28, s64, 139264
s_waitcnt vmcnt(7)
buffer_load_dwordx4 v23, s[4:7], s28 offen offset:0 nt lds
s_waitcnt vmcnt(7)
buffer_load_dwordx4 v23, s[4:7], s28 offen offset:1024 nt lds
v_xor_b32 v23, 160, v110
s_add_u32 m0, s65, 10240
s_add_u32 s28, s64, 141312
s_waitcnt vmcnt(7)
buffer_load_dwordx4 v23, s[4:7], s28 offen offset:0 nt lds
s_waitcnt vmcnt(7)
buffer_load_dwordx4 v23, s[4:7], s28 offen offset:1024 nt lds
s_mov_b32 s33, 200000
LW_9:
ds_read_b32 v13, v2 offset:12
s_sub_u32 s33, s33, 1
s_cbranch_scc1 LE_10
s_waitcnt lgkmcnt(0)
v_readfirstlane_b32 s32, v13
s_nop 0
s_cmp_ge_u32 s32, 4
s_cbranch_scc0 LW_9
LE_10:
s_waitcnt lgkmcnt(0)
v_add_u32 v28, 0x10000, v120
ds_read_b64_tr_b16 v[132:133], v28 offset:0
ds_read_b64_tr_b16 v[134:135], v28 offset:32768
v_add_u32 v29, 0x10000, v121
ds_read_b64_tr_b16 v[140:141], v29 offset:0
ds_read_b64_tr_b16 v[142:143], v29 offset:32768
v_add_u32 v30, 0x10000, v122
ds_read_b64_tr_b16 v[148:149], v30 offset:0
ds_read_b64_tr_b16 v[150:151], v30 offset:32768
v_add_u32 v31, 0x10000, v123
ds_read_b64_tr_b16 v[156:157], v31 offset:0
ds_read_b64_tr_b16 v[158:159], v31 offset:32768
v_add_u32 v28, 0x10000, v124
ds_read_b64_tr_b16 v[164:165], v28 offset:0
ds_read_b64_tr_b16 v[166:167], v28 offset:32768
v_add_u32 v29, 0x10000, v125
ds_read_b64_tr_b16 v[172:173], v29 offset:0
ds_read_b64_tr_b16 v[174:175], v29 offset:32768
v_add_u32 v30, 0x10000, v126
ds_read_b64_tr_b16 v[180:181], v30 offset:0
ds_read_b64_tr_b16 v[182:183], v30 offset:32768
v_add_u32 v31, 0x10000, v127
ds_read_b64_tr_b16 v[188:189], v31 offset:0
ds_read_b64_tr_b16 v[190:191], v31 offset:32768
v_add_u32 v28, 0x10000, v120
ds_read_b64_tr_b16 v[196:197], v28 offset:256
ds_read_b64_tr_b16 v[198:199], v28 offset:33024
v_add_u32 v29, 0x10000, v121
ds_read_b64_tr_b16 v[204:205], v29 offset:256
ds_read_b64_tr_b16 v[206:207], v29 offset:33024
v_add_u32 v30, 0x10000, v122
ds_read_b64_tr_b16 v[212:213], v30 offset:256
ds_read_b64_tr_b16 v[214:215], v30 offset:33024
v_add_u32 v31, 0x10000, v123
ds_read_b64_tr_b16 v[220:221], v31 offset:256
ds_read_b64_tr_b16 v[222:223], v31 offset:33024
v_add_u32 v28, 0x10000, v124
ds_read_b64_tr_b16 v[228:229], v28 offset:256
ds_read_b64_tr_b16 v[230:231], v28 offset:33024
v_add_u32 v29, 0x10000, v125
ds_read_b64_tr_b16 v[236:237], v29 offset:256
ds_read_b64_tr_b16 v[238:239], v29 offset:33024
v_add_u32 v30, 0x10000, v126
ds_read_b64_tr_b16 v[244:245], v30 offset:256
ds_read_b64_tr_b16 v[246:247], v30 offset:33024
v_add_u32 v31, 0x10000, v127
ds_read_b64_tr_b16 v[252:253], v31 offset:256
ds_read_b64_tr_b16 v[254:255], v31 offset:33024
s_waitcnt lgkmcnt(0)
s_mov_b64 exec, 1
ds_add_u32 v2, v3 offset:28
s_mov_b64 exec, -1
v_xor_b32 v23, 192, v110
s_add_u32 m0, s65, 12288
s_add_u32 s28, s64, 143360
s_waitcnt vmcnt(7)
buffer_load_dwordx4 v23, s[4:7], s28 offen offset:0 nt lds
s_waitcnt vmcnt(7)
buffer_load_dwordx4 v23, s[4:7], s28 offen offset:1024 nt lds
v_xor_b32 v23, 224, v110
s_add_u32 m0, s65, 14336
s_add_u32 s28, s64, 145408
s_waitcnt vmcnt(7)
buffer_load_dwordx4 v23, s[4:7], s28 offen offset:0 nt lds
s_waitcnt vmcnt(7)
buffer_load_dwordx4 v23, s[4:7], s28 offen offset:1024 nt lds
s_mov_b32 s33, 200000
LW_11:
ds_read_b32 v13, v2 offset:28
s_sub_u32 s33, s33, 1
s_cbranch_scc1 LE_12
s_waitcnt lgkmcnt(0)
v_readfirstlane_b32 s32, v13
s_nop 0
s_cmp_ge_u32 s32, 8
s_cbranch_scc0 LW_11
LE_12:
s_waitcnt lgkmcnt(0)
v_xor_b32 v23, 0, v110
s_add_u32 m0, s65, 65536
s_add_u32 s28, s64, 196608
s_waitcnt vmcnt(7)
buffer_load_dwordx4 v23, s[4:7], s28 offen offset:0 nt lds
s_waitcnt vmcnt(7)
buffer_load_dwordx4 v23, s[4:7], s28 offen offset:1024 nt lds
v_xor_b32 v23, 32, v110
s_add_u32 m0, s65, 67584
s_add_u32 s28, s64, 198656
s_waitcnt vmcnt(7)
buffer_load_dwordx4 v23, s[4:7], s28 offen offset:0 nt lds
s_waitcnt vmcnt(7)
buffer_load_dwordx4 v23, s[4:7], s28 offen offset:1024 nt lds
v_xor_b32 v23, 64, v110
s_add_u32 m0, s65, 69632
s_add_u32 s28, s64, 200704
s_waitcnt vmcnt(7)
buffer_load_dwordx4 v23, s[4:7], s28 offen offset:0 nt lds
s_waitcnt vmcnt(7)
buffer_load_dwordx4 v23, s[4:7], s28 offen offset:1024 nt lds
v_xor_b32 v23, 96, v110
s_add_u32 m0, s65, 71680
s_add_u32 s28, s64, 202752
s_waitcnt vmcnt(7)
buffer_load_dwordx4 v23, s[4:7], s28 offen offset:0 nt lds
s_waitcnt vmcnt(7)
s_waitcnt lgkmcnt(0)
s_mov_b64 exec, 1
ds_add_u32 v2, v3 offset:16
s_mov_b64 exec, -1
buffer_load_dwordx4 v23, s[4:7], s28 offen offset:1024 nt lds
v_xor_b32 v23, 128, v110
s_add_u32 m0, s65, 73728
s_add_u32 s28, s64, 204800
s_waitcnt vmcnt(7)
buffer_load_dwordx4 v23, s[4:7], s28 offen offset:0 nt lds
s_waitcnt vmcnt(7)
buffer_load_dwordx4 v23, s[4:7], s28 offen offset:1024 nt lds
v_xor_b32 v23, 160, v110
s_add_u32 m0, s65, 75776
s_add_u32 s28, s64, 206848
s_waitcnt vmcnt(7)
buffer_load_dwordx4 v23, s[4:7], s28 offen offset:0 nt lds
s_waitcnt vmcnt(7)
buffer_load_dwordx4 v23, s[4:7], s28 offen offset:1024 nt lds
v_xor_b32 v23, 192, v110
s_add_u32 m0, s65, 77824
s_add_u32 s28, s64, 208896
s_waitcnt vmcnt(7)
buffer_load_dwordx4 v23, s[4:7], s28 offen offset:0 nt lds
s_waitcnt vmcnt(7)
buffer_load_dwordx4 v23, s[4:7], s28 offen offset:1024 nt lds
v_xor_b32 v23, 224, v110
s_add_u32 m0, s65, 79872
s_add_u32 s28, s64, 210944
s_waitcnt vmcnt(7)
buffer_load_dwordx4 v23, s[4:7], s28 offen offset:0 nt lds
s_waitcnt vmcnt(7)
buffer_load_dwordx4 v23, s[4:7], s28 offen offset:1024 nt lds
s_waitcnt vmcnt(0)
s_waitcnt lgkmcnt(0)
s_mov_b64 exec, 1
ds_add_u32 v2, v3 offset:20
s_mov_b64 exec, -1
C_join:
s_nop 11
s_cmp_eq_u32 s3, 1
s_cbranch_scc1 C_q1
s_waitcnt lgkmcnt(0)
s_mov_b64 exec, 1
ds_add_u32 v2, v3 offset:4
s_mov_b64 exec, -1
s_branch C_q2
C_q1:
v_readfirstlane_b32 s31, v0
s_nop 0
s_and_b32 s34, s31, 7
s_lshl_b32 s34, s34, 3
s_bfe_u32 s35, s31, 0x30003
s_add_u32 s34, s34, s35
s_lshl_b32 s34, s34, 8
s_lshr_b32 s35, s16, 16
s_mov_b32 s33, 25000
SP_13:
s_load_dwordx16 s[36:51], s[12:13], s34 offset:147648 glc
s_sub_u32 s33, s33, 1
s_cbranch_scc1 SE_14
s_waitcnt lgkmcnt(0)
s_and_b64 s[28:29], s[36:37], s[38:39]
s_or_b64 s[30:31], s[36:37], s[38:39]
s_and_b64 s[28:29], s[28:29], s[40:41]
s_or_b64 s[30:31], s[30:31], s[40:41]
s_and_b64 s[28:29], s[28:29], s[42:43]
s_or_b64 s[30:31], s[30:31], s[42:43]
s_and_b64 s[28:29], s[28:29], s[44:45]
s_or_b64 s[30:31], s[30:31], s[44:45]
s_and_b64 s[28:29], s[28:29], s[46:47]
s_or_b64 s[30:31], s[30:31], s[46:47]
s_and_b64 s[28:29], s[28:29], s[48:49]
s_or_b64 s[30:31], s[30:31], s[48:49]
s_and_b64 s[28:29], s[28:29], s[50:51]
s_or_b64 s[30:31], s[30:31], s[50:51]
s_xor_b32 s28, s28, s16
s_xor_b32 s29, s29, s35
s_xor_b32 s30, s30, s16
s_xor_b32 s31, s31, s35
s_or_b64 s[28:29], s[28:29], s[30:31]
s_or_b32 s28, s28, s29
s_and_b32 s28, s28, 0xffff
s_cbranch_scc0 SE_14
s_sleep 4
s_branch SP_13
SE_14:
s_waitcnt lgkmcnt(0)
v_lshlrev_b32 v96, 4, v1
v_readfirstlane_b32 s31, v0
s_nop 0
s_and_b32 s35, s31, 7
s_lshl_b32 s35, s35, 11
s_add_u32 s35, s35, 147456
buffer_load_dwordx4 v[100:103], v96, s[12:15], s35 offen sc1
buffer_load_dwordx4 v[104:107], v96, s[12:15], s35 offen offset:1024 sc1
s_mov_b32 s33, 25000
QA_15:
s_waitcnt vmcnt(0)
s_lshr_b32 s34, s16, 16
v_xor_b32 v15, s16, v100
v_bitop3_b32 v15, v102, s16, v15 bitop3:0xbe
v_bitop3_b32 v15, v104, s16, v15 bitop3:0xbe
v_bitop3_b32 v15, v106, s16, v15 bitop3:0xbe
v_and_b32 v14, 0xffff, v15
v_xor_b32 v15, s34, v101
v_bitop3_b32 v15, v103, s34, v15 bitop3:0xbe
v_bitop3_b32 v15, v105, s34, v15 bitop3:0xbe
v_bitop3_b32 v15, v107, s34, v15 bitop3:0xbe
v_and_b32 v15, 0xffff, v15
v_or_b32 v14, v14, v15
v_cmp_ne_u32 vcc, 0, v14
s_nop 4
s_cbranch_vccz QE_16
s_sub_u32 s33, s33, 1
s_cbranch_scc1 QE_16
v_lshlrev_b32 v96, 4, v1
v_readfirstlane_b32 s31, v0
s_nop 0
s_and_b32 s35, s31, 7
s_lshl_b32 s35, s35, 11
s_add_u32 s35, s35, 147456
buffer_load_dwordx4 v[100:103], v96, s[12:15], s35 offen sc1
buffer_load_dwordx4 v[104:107], v96, s[12:15], s35 offen offset:1024 sc1
s_branch QA_15
QE_16:
v_perm_b32 v20, v101, v100, v16
v_perm_b32 v21, v103, v102, v16
v_perm_b32 v22, v105, v104, v16
v_perm_b32 v23, v107, v106, v16
v_lshlrev_b32 v24, 3, v1
v_add_u32 v24, 160768, v24
ds_write_b64 v24, v[20:21]
ds_write_b64 v24, v[22:23] offset:512
s_waitcnt lgkmcnt(0)
s_mov_b64 exec, 1
ds_add_u32 v2, v3 offset:4
s_mov_b64 exec, -1
C_q2:
s_nop 11
s_cmp_lt_u32 s2, 192
s_cbranch_scc1 C_noB
v_lshlrev_b32 v24, 4, v1
v_add_u32 v24, 131072, v24
s_lshl_b32 s34, s3, 12
s_add_u32 s34, s34, 12288
v_add_u32 v25, s34, v24
v_and_b32 v27, 15, v1
v_lshlrev_b32 v27, 5, v27
v_add_u32 v27, 159744, v27
s_lshl_b32 s34, s3, 2
v_add_u32 v28, s34, v27
s_lshl_b32 s34, s3, 9
s_add_u32 s34, s34, 155648
v_lshl_add_u32 v29, v1, 3, s34
s_mov_b32 s35, 0x3db8aa3b
s_waitcnt lgkmcnt(0)
s_barrier
ds_read_b128 v[96:99], v25 offset:0
ds_read_b128 v[100:103], v25 offset:1024
ds_read_b128 v[104:107], v25 offset:2048
ds_read_b128 v[20:23], v25 offset:3072
s_waitcnt lgkmcnt(0)
v_add_f32 v20, v20, v96
v_add_f32 v100, v100, v104
v_add_f32 v21, v21, v97
v_add_f32 v101, v101, v105
v_add_f32 v22, v22, v98
v_add_f32 v102, v102, v106
v_add_f32 v23, v23, v99
v_add_f32 v103, v103, v107
v_add_f32 v20, v20, v100
v_add_f32 v21, v21, v101
v_add_f32 v22, v22, v102
v_add_f32 v23, v23, v103
v_max3_f32 v26, v20, v21, v22
v_max_f32 v26, v26, v23
v_mov_b32 v30, v26
s_nop 1
v_permlane16_swap_b32 v26, v30
v_max_f32 v26, v26, v30
v_mov_b32 v30, v26
s_nop 1
v_permlane32_swap_b32 v26, v30
v_max_f32 v26, v26, v30
s_mov_b64 exec, 0xffff
ds_write_b32 v28, v26 offset:0
s_mov_b64 exec, -1
s_waitcnt lgkmcnt(0)
s_barrier
ds_read_b128 v[96:99], v27
ds_read_b128 v[100:103], v27 offset:16
s_waitcnt lgkmcnt(0)
v_max3_f32 v26, v96, v97, v98
v_max3_f32 v30, v99, v100, v101
v_max3_f32 v26, v26, v102, v103
v_max_f32 v26, v26, v30
v_mul_f32 v26, s35, v26
v_and_b32 v26, v19, v26
v_fma_f32 v20, v20, s35, -v26
v_fma_f32 v21, v21, s35, -v26
v_fma_f32 v22, v22, s35, -v26
v_fma_f32 v23, v23, s35, -v26
v_exp_f32 v20, v20
v_exp_f32 v21, v21
v_exp_f32 v22, v22
v_exp_f32 v23, v23
v_cvt_pk_bf16_f32 v96, v20, v21
v_cvt_pk_bf16_f32 v97, v22, v23
ds_write_b64 v29, v[96:97]
v_add_f32 v20, v20, v21
v_add_f32 v22, v22, v23
v_add_f32 v20, v20, v22
v_mov_b32 v30, v20
s_nop 1
v_permlane16_swap_b32 v20, v30
v_add_f32 v20, v20, v30
v_mov_b32 v30, v20
s_nop 1
v_permlane32_swap_b32 v20, v30
v_add_f32 v20, v20, v30
s_mov_b64 exec, 0xffff
ds_write_b32 v28, v20 offset:512
s_mov_b64 exec, -1
s_waitcnt lgkmcnt(0)
s_barrier
v_lshlrev_b32 v24, 3, v1
v_add_u32 v24, 155648, v24
ds_read_b64 v[96:97], v24 offset:0
ds_read_b64 v[98:99], v24 offset:512
ds_read_b64 v[100:101], v24 offset:1024
ds_read_b64 v[102:103], v24 offset:1536
ds_read_b64 v[104:105], v24 offset:2048
ds_read_b64 v[106:107], v24 offset:2560
ds_read_b64 v[108:109], v24 offset:3072
ds_read_b64 v[110:111], v24 offset:3584
v_lshrrev_b32 v25, 4, v1
v_lshlrev_b32 v25, 19, v25
v_and_b32 v21, 15, v1
v_lshl_add_u32 v25, v21, 4, v25
s_sub_u32 s36, s2, 192
s_lshl_b32 s36, s36, 9
s_lshl_b32 s29, s3, 15
s_add_u32 s36, s36, s29
s_add_u32 s36, s36, 1048576
s_add_u32 s37, s36, 131072
s_add_u32 s38, s36, 262144
s_add_u32 s39, s36, 393216
s_cmp_lg_u32 s3, 0
s_cbranch_scc1 C_noLST
ds_read_b128 v[112:115], v27 offset:512
ds_read_b128 v[116:119], v27 offset:528
s_waitcnt lgkmcnt(0)
v_add_f32 v112, v112, v116
v_add_f32 v113, v113, v117
v_add_f32 v114, v114, v118
v_add_f32 v115, v115, v119
v_add_f32 v112, v112, v113
v_add_f32 v114, v114, v115
v_add_f32 v112, v112, v114
v_or_b32 v22, s17, v26
v_and_or_b32 v23, v112, v19, s18
v_lshlrev_b32 v21, 9, v1
s_sub_u32 s28, s2, 192
s_lshl_b32 s28, s28, 3
s_add_u32 s28, s28, 311296
s_mov_b64 exec, 0xffff
buffer_store_dwordx2 v[22:23], v21, s[12:15], s28 offen sc1
s_mov_b64 exec, -1
C_noLST:
s_waitcnt lgkmcnt(0)
v_mfma_f32_16x16x32_bf16 v[32:35], v[96:99], v[128:131], 0
v_mfma_f32_16x16x32_bf16 v[32:35], v[100:103], v[132:135], v[32:35]
ds_read_b64_tr_b16 v[128:129], v120 offset:0
ds_read_b64_tr_b16 v[130:131], v120 offset:32768
v_add_u32 v28, 0x10000, v120
ds_read_b64_tr_b16 v[132:133], v28 offset:0
ds_read_b64_tr_b16 v[134:135], v28 offset:32768
v_mfma_f32_16x16x32_bf16 v[36:39], v[96:99], v[136:139], 0
v_mfma_f32_16x16x32_bf16 v[36:39], v[100:103], v[140:143], v[36:39]
ds_read_b64_tr_b16 v[136:137], v121 offset:0
ds_read_b64_tr_b16 v[138:139], v121 offset:32768
v_add_u32 v29, 0x10000, v121
ds_read_b64_tr_b16 v[140:141], v29 offset:0
ds_read_b64_tr_b16 v[142:143], v29 offset:32768
v_mfma_f32_16x16x32_bf16 v[40:43], v[96:99], v[144:147], 0
v_mfma_f32_16x16x32_bf16 v[40:43], v[100:103], v[148:151], v[40:43]
ds_read_b64_tr_b16 v[144:145], v122 offset:0
ds_read_b64_tr_b16 v[146:147], v122 offset:32768
v_add_u32 v30, 0x10000, v122
ds_read_b64_tr_b16 v[148:149], v30 offset:0
ds_read_b64_tr_b16 v[150:151], v30 offset:32768
v_mfma_f32_16x16x32_bf16 v[44:47], v[96:99], v[152:155], 0
v_mfma_f32_16x16x32_bf16 v[44:47], v[100:103], v[156:159], v[44:47]
ds_read_b64_tr_b16 v[152:153], v123 offset:0
ds_read_b64_tr_b16 v[154:155], v123 offset:32768
v_add_u32 v31, 0x10000, v123
ds_read_b64_tr_b16 v[156:157], v31 offset:0
ds_read_b64_tr_b16 v[158:159], v31 offset:32768
v_mfma_f32_16x16x32_bf16 v[48:51], v[96:99], v[160:163], 0
v_mfma_f32_16x16x32_bf16 v[48:51], v[100:103], v[164:167], v[48:51]
ds_read_b64_tr_b16 v[160:161], v124 offset:0
ds_read_b64_tr_b16 v[162:163], v124 offset:32768
v_add_u32 v28, 0x10000, v124
ds_read_b64_tr_b16 v[164:165], v28 offset:0
ds_read_b64_tr_b16 v[166:167], v28 offset:32768
v_mfma_f32_16x16x32_bf16 v[52:55], v[96:99], v[168:171], 0
v_mfma_f32_16x16x32_bf16 v[52:55], v[100:103], v[172:175], v[52:55]
ds_read_b64_tr_b16 v[168:169], v125 offset:0
ds_read_b64_tr_b16 v[170:171], v125 offset:32768
v_add_u32 v29, 0x10000, v125
ds_read_b64_tr_b16 v[172:173], v29 offset:0
ds_read_b64_tr_b16 v[174:175], v29 offset:32768
v_mfma_f32_16x16x32_bf16 v[56:59], v[96:99], v[176:179], 0
v_mfma_f32_16x16x32_bf16 v[56:59], v[100:103], v[180:183], v[56:59]
ds_read_b64_tr_b16 v[176:177], v126 offset:0
ds_read_b64_tr_b16 v[178:179], v126 offset:32768
v_add_u32 v30, 0x10000, v126
ds_read_b64_tr_b16 v[180:181], v30 offset:0
ds_read_b64_tr_b16 v[182:183], v30 offset:32768
v_mfma_f32_16x16x32_bf16 v[60:63], v[96:99], v[184:187], 0
v_mfma_f32_16x16x32_bf16 v[60:63], v[100:103], v[188:191], v[60:63]
ds_read_b64_tr_b16 v[184:185], v127 offset:0
ds_read_b64_tr_b16 v[186:187], v127 offset:32768
v_add_u32 v31, 0x10000, v127
ds_read_b64_tr_b16 v[188:189], v31 offset:0
ds_read_b64_tr_b16 v[190:191], v31 offset:32768
v_mfma_f32_16x16x32_bf16 v[64:67], v[96:99], v[192:195], 0
v_mfma_f32_16x16x32_bf16 v[64:67], v[100:103], v[196:199], v[64:67]
ds_read_b64_tr_b16 v[192:193], v120 offset:256
ds_read_b64_tr_b16 v[194:195], v120 offset:33024
v_add_u32 v28, 0x10000, v120
ds_read_b64_tr_b16 v[196:197], v28 offset:256
ds_read_b64_tr_b16 v[198:199], v28 offset:33024
v_mfma_f32_16x16x32_bf16 v[68:71], v[96:99], v[200:203], 0
v_mfma_f32_16x16x32_bf16 v[68:71], v[100:103], v[204:207], v[68:71]
ds_read_b64_tr_b16 v[200:201], v121 offset:256
ds_read_b64_tr_b16 v[202:203], v121 offset:33024
v_add_u32 v29, 0x10000, v121
ds_read_b64_tr_b16 v[204:205], v29 offset:256
ds_read_b64_tr_b16 v[206:207], v29 offset:33024
v_mfma_f32_16x16x32_bf16 v[72:75], v[96:99], v[208:211], 0
v_mfma_f32_16x16x32_bf16 v[72:75], v[100:103], v[212:215], v[72:75]
ds_read_b64_tr_b16 v[208:209], v122 offset:256
ds_read_b64_tr_b16 v[210:211], v122 offset:33024
v_add_u32 v30, 0x10000, v122
ds_read_b64_tr_b16 v[212:213], v30 offset:256
ds_read_b64_tr_b16 v[214:215], v30 offset:33024
v_mfma_f32_16x16x32_bf16 v[76:79], v[96:99], v[216:219], 0
v_mfma_f32_16x16x32_bf16 v[76:79], v[100:103], v[220:223], v[76:79]
ds_read_b64_tr_b16 v[216:217], v123 offset:256
ds_read_b64_tr_b16 v[218:219], v123 offset:33024
v_add_u32 v31, 0x10000, v123
ds_read_b64_tr_b16 v[220:221], v31 offset:256
ds_read_b64_tr_b16 v[222:223], v31 offset:33024
v_mfma_f32_16x16x32_bf16 v[80:83], v[96:99], v[224:227], 0
v_mfma_f32_16x16x32_bf16 v[80:83], v[100:103], v[228:231], v[80:83]
ds_read_b64_tr_b16 v[224:225], v124 offset:256
ds_read_b64_tr_b16 v[226:227], v124 offset:33024
v_add_u32 v28, 0x10000, v124
ds_read_b64_tr_b16 v[228:229], v28 offset:256
ds_read_b64_tr_b16 v[230:231], v28 offset:33024
v_mfma_f32_16x16x32_bf16 v[84:87], v[96:99], v[232:235], 0
v_mfma_f32_16x16x32_bf16 v[84:87], v[100:103], v[236:239], v[84:87]
ds_read_b64_tr_b16 v[232:233], v125 offset:256
ds_read_b64_tr_b16 v[234:235], v125 offset:33024
v_add_u32 v29, 0x10000, v125
ds_read_b64_tr_b16 v[236:237], v29 offset:256
ds_read_b64_tr_b16 v[238:239], v29 offset:33024
v_mfma_f32_16x16x32_bf16 v[88:91], v[96:99], v[240:243], 0
v_mfma_f32_16x16x32_bf16 v[88:91], v[100:103], v[244:247], v[88:91]
ds_read_b64_tr_b16 v[240:241], v126 offset:256
ds_read_b64_tr_b16 v[242:243], v126 offset:33024
v_add_u32 v30, 0x10000, v126
ds_read_b64_tr_b16 v[244:245], v30 offset:256
ds_read_b64_tr_b16 v[246:247], v30 offset:33024
v_mfma_f32_16x16x32_bf16 v[92:95], v[96:99], v[248:251], 0
v_mfma_f32_16x16x32_bf16 v[92:95], v[100:103], v[252:255], v[92:95]
ds_read_b64_tr_b16 v[248:249], v127 offset:256
ds_read_b64_tr_b16 v[250:251], v127 offset:33024
v_add_u32 v31, 0x10000, v127
ds_read_b64_tr_b16 v[252:253], v31 offset:256
ds_read_b64_tr_b16 v[254:255], v31 offset:33024
v_and_b32 v26, 3, v1
v_lshlrev_b32 v26, 3, v26
v_lshrrev_b32 v26, v26, s16
v_bfe_u32 v27, v26, 1, 1
v_bfe_u32 v20, v26, 0, 1
v_lshl_or_b32 v20, v27, 16, v20
v_bfe_u32 v27, v26, 3, 1
v_bfe_u32 v21, v26, 2, 1
v_lshl_or_b32 v21, v27, 16, v21
v_bfe_u32 v27, v26, 5, 1
v_bfe_u32 v22, v26, 4, 1
v_lshl_or_b32 v22, v27, 16, v22
v_bfe_u32 v27, v26, 7, 1
v_bfe_u32 v23, v26, 6, 1
v_lshl_or_b32 v23, v27, 16, v23
s_waitcnt lgkmcnt(15)
v_mfma_f32_16x16x32_bf16 v[32:35], v[104:107], v[128:131], v[32:35]
v_mfma_f32_16x16x32_bf16 v[32:35], v[108:111], v[132:135], v[32:35]
s_waitcnt lgkmcnt(15)
v_mfma_f32_16x16x32_bf16 v[36:39], v[104:107], v[136:139], v[36:39]
v_mfma_f32_16x16x32_bf16 v[36:39], v[108:111], v[140:143], v[36:39]
s_waitcnt lgkmcnt(15)
v_mfma_f32_16x16x32_bf16 v[40:43], v[104:107], v[144:147], v[40:43]
v_mfma_f32_16x16x32_bf16 v[40:43], v[108:111], v[148:151], v[40:43]
s_waitcnt lgkmcnt(15)
v_mfma_f32_16x16x32_bf16 v[44:47], v[104:107], v[152:155], v[44:47]
v_mfma_f32_16x16x32_bf16 v[44:47], v[108:111], v[156:159], v[44:47]
s_waitcnt lgkmcnt(15)
v_mfma_f32_16x16x32_bf16 v[48:51], v[104:107], v[160:163], v[48:51]
v_mfma_f32_16x16x32_bf16 v[48:51], v[108:111], v[164:167], v[48:51]
s_waitcnt lgkmcnt(15)
v_mfma_f32_16x16x32_bf16 v[52:55], v[104:107], v[168:171], v[52:55]
v_mfma_f32_16x16x32_bf16 v[52:55], v[108:111], v[172:175], v[52:55]
s_waitcnt lgkmcnt(15)
v_mfma_f32_16x16x32_bf16 v[56:59], v[104:107], v[176:179], v[56:59]
v_mfma_f32_16x16x32_bf16 v[56:59], v[108:111], v[180:183], v[56:59]
s_waitcnt lgkmcnt(15)
v_mfma_f32_16x16x32_bf16 v[60:63], v[104:107], v[184:187], v[60:63]
v_mfma_f32_16x16x32_bf16 v[60:63], v[108:111], v[188:191], v[60:63]
s_waitcnt lgkmcnt(15)
v_mfma_f32_16x16x32_bf16 v[64:67], v[104:107], v[192:195], v[64:67]
v_mfma_f32_16x16x32_bf16 v[64:67], v[108:111], v[196:199], v[64:67]
s_waitcnt lgkmcnt(15)
v_mfma_f32_16x16x32_bf16 v[68:71], v[104:107], v[200:203], v[68:71]
v_mfma_f32_16x16x32_bf16 v[68:71], v[108:111], v[204:207], v[68:71]
v_perm_b32 v112, v36, v32, v16
v_add_u32 v112, 0x00010001, v112
v_and_or_b32 v112, v112, v17, v20
v_perm_b32 v113, v44, v40, v16
v_add_u32 v113, 0x00010001, v113
v_and_or_b32 v113, v113, v17, v21
v_perm_b32 v114, v52, v48, v16
v_add_u32 v114, 0x00010001, v114
v_and_or_b32 v114, v114, v17, v22
v_perm_b32 v115, v60, v56, v16
v_add_u32 v115, 0x00010001, v115
v_and_or_b32 v115, v115, v17, v23
buffer_store_dwordx4 v[112:115], v25, s[12:15], s36 offen offset:0 sc1
s_waitcnt lgkmcnt(15)
v_mfma_f32_16x16x32_bf16 v[72:75], v[104:107], v[208:211], v[72:75]
v_mfma_f32_16x16x32_bf16 v[72:75], v[108:111], v[212:215], v[72:75]
s_waitcnt lgkmcnt(15)
v_mfma_f32_16x16x32_bf16 v[76:79], v[104:107], v[216:219], v[76:79]
v_mfma_f32_16x16x32_bf16 v[76:79], v[108:111], v[220:223], v[76:79]
v_perm_b32 v116, v37, v33, v16
v_add_u32 v116, 0x00010001, v116
v_and_or_b32 v116, v116, v17, v20
v_perm_b32 v117, v45, v41, v16
v_add_u32 v117, 0x00010001, v117
v_and_or_b32 v117, v117, v17, v21
v_perm_b32 v118, v53, v49, v16
v_add_u32 v118, 0x00010001, v118
v_and_or_b32 v118, v118, v17, v22
v_perm_b32 v119, v61, v57, v16
v_add_u32 v119, 0x00010001, v119
v_and_or_b32 v119, v119, v17, v23
buffer_store_dwordx4 v[116:119], v25, s[12:15], s37 offen offset:0 sc1
s_waitcnt lgkmcnt(12)
v_mfma_f32_16x16x32_bf16 v[80:83], v[104:107], v[224:227], v[80:83]
v_mfma_f32_16x16x32_bf16 v[80:83], v[108:111], v[228:231], v[80:83]
s_waitcnt lgkmcnt(8)
v_mfma_f32_16x16x32_bf16 v[84:87], v[104:107], v[232:235], v[84:87]
v_mfma_f32_16x16x32_bf16 v[84:87], v[108:111], v[236:239], v[84:87]
v_perm_b32 v120, v38, v34, v16
v_add_u32 v120, 0x00010001, v120
v_and_or_b32 v120, v120, v17, v20
v_perm_b32 v121, v46, v42, v16
v_add_u32 v121, 0x00010001, v121
v_and_or_b32 v121, v121, v17, v21
v_perm_b32 v122, v54, v50, v16
v_add_u32 v122, 0x00010001, v122
v_and_or_b32 v122, v122, v17, v22
v_perm_b32 v123, v62, v58, v16
v_add_u32 v123, 0x00010001, v123
v_and_or_b32 v123, v123, v17, v23
buffer_store_dwordx4 v[120:123], v25, s[12:15], s38 offen offset:0 sc1
s_waitcnt lgkmcnt(4)
v_mfma_f32_16x16x32_bf16 v[88:91], v[104:107], v[240:243], v[88:91]
v_mfma_f32_16x16x32_bf16 v[88:91], v[108:111], v[244:247], v[88:91]
s_waitcnt lgkmcnt(0)
v_mfma_f32_16x16x32_bf16 v[92:95], v[104:107], v[248:251], v[92:95]
v_mfma_f32_16x16x32_bf16 v[92:95], v[108:111], v[252:255], v[92:95]
v_perm_b32 v124, v39, v35, v16
v_add_u32 v124, 0x00010001, v124
v_and_or_b32 v124, v124, v17, v20
v_perm_b32 v125, v47, v43, v16
v_add_u32 v125, 0x00010001, v125
v_and_or_b32 v125, v125, v17, v21
v_perm_b32 v126, v55, v51, v16
v_add_u32 v126, 0x00010001, v126
v_and_or_b32 v126, v126, v17, v22
v_perm_b32 v127, v63, v59, v16
v_add_u32 v127, 0x00010001, v127
v_and_or_b32 v127, v127, v17, v23
buffer_store_dwordx4 v[124:127], v25, s[12:15], s39 offen offset:0 sc1
v_perm_b32 v128, v68, v64, v16
v_add_u32 v128, 0x00010001, v128
v_and_or_b32 v128, v128, v17, v20
v_perm_b32 v129, v76, v72, v16
v_add_u32 v129, 0x00010001, v129
v_and_or_b32 v129, v129, v17, v21
v_perm_b32 v130, v84, v80, v16
v_add_u32 v130, 0x00010001, v130
v_and_or_b32 v130, v130, v17, v22
v_perm_b32 v131, v92, v88, v16
v_add_u32 v131, 0x00010001, v131
v_and_or_b32 v131, v131, v17, v23
buffer_store_dwordx4 v[128:131], v25, s[12:15], s36 offen offset:256 sc1
v_perm_b32 v132, v69, v65, v16
v_add_u32 v132, 0x00010001, v132
v_and_or_b32 v132, v132, v17, v20
v_perm_b32 v133, v77, v73, v16
v_add_u32 v133, 0x00010001, v133
v_and_or_b32 v133, v133, v17, v21
v_perm_b32 v134, v85, v81, v16
v_add_u32 v134, 0x00010001, v134
v_and_or_b32 v134, v134, v17, v22
v_perm_b32 v135, v93, v89, v16
v_add_u32 v135, 0x00010001, v135
v_and_or_b32 v135, v135, v17, v23
buffer_store_dwordx4 v[132:135], v25, s[12:15], s37 offen offset:256 sc1
v_perm_b32 v136, v70, v66, v16
v_add_u32 v136, 0x00010001, v136
v_and_or_b32 v136, v136, v17, v20
v_perm_b32 v137, v78, v74, v16
v_add_u32 v137, 0x00010001, v137
v_and_or_b32 v137, v137, v17, v21
v_perm_b32 v138, v86, v82, v16
v_add_u32 v138, 0x00010001, v138
v_and_or_b32 v138, v138, v17, v22
v_perm_b32 v139, v94, v90, v16
v_add_u32 v139, 0x00010001, v139
v_and_or_b32 v139, v139, v17, v23
buffer_store_dwordx4 v[136:139], v25, s[12:15], s38 offen offset:256 sc1
v_perm_b32 v140, v71, v67, v16
v_add_u32 v140, 0x00010001, v140
v_and_or_b32 v140, v140, v17, v20
v_perm_b32 v141, v79, v75, v16
v_add_u32 v141, 0x00010001, v141
v_and_or_b32 v141, v141, v17, v21
v_perm_b32 v142, v87, v83, v16
v_add_u32 v142, 0x00010001, v142
v_and_or_b32 v142, v142, v17, v22
v_perm_b32 v143, v95, v91, v16
v_add_u32 v143, 0x00010001, v143
v_and_or_b32 v143, v143, v17, v23
buffer_store_dwordx4 v[140:143], v25, s[12:15], s39 offen offset:256 sc1
v_lshlrev_b32 v21, 10, v1
v_mov_b32 v23, s16
s_sub_u32 s28, s2, 192
s_lshl_b32 s28, s28, 2
s_lshl_b32 s29, s3, 8
s_add_u32 s28, s28, s29
s_add_u32 s28, s28, 303104
s_mov_b64 exec, 0xff
buffer_store_dword v23, v21, s[12:15], s28 offen sc1
s_mov_b64 exec, -1
s_waitcnt lgkmcnt(0)
s_mov_b64 exec, 1
ds_add_u32 v2, v3 offset:64
s_mov_b64 exec, -1
s_branch C_go
C_noB:
s_mov_b32 s33, 200000
LW_17:
ds_read_b32 v13, v2 offset:52
s_sub_u32 s33, s33, 1
s_cbranch_scc1 LE_18
s_waitcnt lgkmcnt(0)
v_readfirstlane_b32 s32, v13
s_nop 0
s_cmp_ge_u32 s32, 1
s_cbranch_scc1 LE_18
s_sleep 4
s_branch LW_17
LE_18:
s_waitcnt lgkmcnt(0)
C_go:
s_nop 11
s_mov_b32 s4, s20
s_mov_b32 s5, s21
s_mov_b32 s6, 8388608
s_mov_b32 s7, 0x00020000
v_lshrrev_b32 v20, 4, v1
v_lshlrev_b32 v20, 17, v20
v_and_b32 v21, 15, v1
v_lshl_add_u32 v20, v21, 4, v20
s_and_b32 s28, s2, 7
s_lshl_b32 s28, s28, 20
s_lshl_b32 s29, s3, 15
s_add_u32 s28, s28, s29
s_lshr_b32 s29, s2, 3
s_lshl_b32 s29, s29, 8
s_add_u32 s28, s28, s29
s_add_u32 s29, s28, 0
buffer_load_dwordx4 v[160:163], v20, s[4:7], s29 offen nt
s_add_u32 s29, s28, 8192
buffer_load_dwordx4 v[164:167], v20, s[4:7], s29 offen nt
s_add_u32 s29, s28, 16384
buffer_load_dwordx4 v[168:171], v20, s[4:7], s29 offen nt
s_add_u32 s29, s28, 24576
buffer_load_dwordx4 v[172:175], v20, s[4:7], s29 offen nt
s_add_u32 s29, s28, 524288
buffer_load_dwordx4 v[176:179], v20, s[4:7], s29 offen nt
s_add_u32 s29, s28, 532480
buffer_load_dwordx4 v[180:183], v20, s[4:7], s29 offen nt
s_add_u32 s29, s28, 540672
buffer_load_dwordx4 v[184:187], v20, s[4:7], s29 offen nt
s_add_u32 s29, s28, 548864
buffer_load_dwordx4 v[188:191], v20, s[4:7], s29 offen nt
v_lshrrev_b32 v29, 4, v1
v_lshlrev_b32 v30, 11, v29
v_and_b32 v31, 15, v1
v_lshl_add_u32 v30, v31, 4, v30
s_lshl_b32 s28, s3, 8
s_add_u32 s28, s28, 139264
v_lshl_add_u32 v86, v29, 4, s28
v_lshlrev_b32 v29, 5, v29
v_and_b32 v20, 8, v1
v_cmp_ne_u32 vcc, 0, v20
s_nop 1
v_cndmask_b32 v80, v4, v8, vcc
v_cndmask_b32 v81, v5, v9, vcc
v_cndmask_b32 v82, v6, v10, vcc
v_cndmask_b32 v83, v7, v11, vcc
s_lshl_b32 s28, s3, 3
s_add_u32 s28, s28, 162944
v_mov_b32 v84, s28
v_mov_b32 v31, 162944
s_lshl_b32 s28, s3, 10
s_add_u32 s29, s28, 139264
v_lshl_add_u32 v85, v1, 4, s29
s_add_u32 s28, s28, 131072
v_lshl_add_u32 v87, v1, 4, s28
v_and_b32 v20, 3, v1
v_lshlrev_b32 v20, 3, v20
v_lshrrev_b32 v20, v20, s16
v_bfe_u32 v21, v20, 1, 1
v_bfe_u32 v108, v20, 0, 1
v_lshl_or_b32 v108, v21, 16, v108
v_bfe_u32 v21, v20, 3, 1
v_bfe_u32 v109, v20, 2, 1
v_lshl_or_b32 v109, v21, 16, v109
v_bfe_u32 v21, v20, 5, 1
v_bfe_u32 v110, v20, 4, 1
v_lshl_or_b32 v110, v21, 16, v110
v_bfe_u32 v21, v20, 7, 1
v_bfe_u32 v111, v20, 6, 1
v_lshl_or_b32 v111, v21, 16, v111
s_bfe_u32 s34, s2, 0x30004
s_lshl_b32 s34, s34, 10
s_bfe_u32 s62, s2, 0x20001
s_lshl_b32 s35, s62, 8
s_add_u32 s34, s34, s35
s_lshl_b32 s35, s3, 6
s_add_u32 s34, s34, s35
s_lshr_b32 s61, s2, 4
s_lshl_b32 s60, s61, 2
s_add_u32 s60, s60, s62
s_lshl_b32 s60, s60, 15
s_lshl_b32 s35, s3, 13
s_add_u32 s60, s60, s35
s_and_b32 s35, s2, 1
s_lshl_b32 s35, s35, 8
s_add_u32 s60, s60, s35
s_add_u32 s60, s60, 1048576
s_lshl_b32 s61, s61, 9
s_lshl_b32 s35, s3, 7
s_add_u32 s61, s61, s35
s_add_u32 s61, s61, 311296
s_mov_b32 s33, 25000
SP_19:
s_load_dwordx16 s[36:51], s[12:13], s34 offset:303104 glc
s_sub_u32 s33, s33, 1
s_cbranch_scc1 SE_20
s_waitcnt lgkmcnt(0)
s_cmp_eq_u32 s36, s16
s_cbranch_scc1 SK_21
s_cmp_eq_u32 s43, s16
s_cbranch_scc1 SK_21
s_sleep 20
s_branch SP_19
SK_21:
s_and_b64 s[28:29], s[36:37], s[38:39]
s_or_b64 s[30:31], s[36:37], s[38:39]
s_and_b64 s[28:29], s[28:29], s[40:41]
s_or_b64 s[30:31], s[30:31], s[40:41]
s_and_b64 s[28:29], s[28:29], s[42:43]
s_or_b64 s[30:31], s[30:31], s[42:43]
s_and_b64 s[28:29], s[28:29], s[44:45]
s_or_b64 s[30:31], s[30:31], s[44:45]
s_and_b64 s[28:29], s[28:29], s[46:47]
s_or_b64 s[30:31], s[30:31], s[46:47]
s_and_b64 s[28:29], s[28:29], s[48:49]
s_or_b64 s[30:31], s[30:31], s[48:49]
s_and_b64 s[28:29], s[28:29], s[50:51]
s_or_b64 s[30:31], s[30:31], s[50:51]
s_and_b32 s28, s28, s29
s_or_b32 s30, s30, s31
s_xor_b32 s28, s28, s16
s_xor_b32 s30, s30, s16
s_or_b32 s28, s28, s30
s_and_b32 s28, s28, -1
s_cbranch_scc1 SP_19
SE_20:
s_waitcnt lgkmcnt(0)
s_mov_b32 s36, 25000
G4_22:
buffer_load_dwordx4 v[64:67], v29, s[12:15], s61 offen sc1
buffer_load_dwordx4 v[68:71], v29, s[12:15], s61 offen offset:16 sc1
buffer_load_dwordx4 v[32:35], v30, s[12:15], s60 offen offset:0 sc1
buffer_load_dwordx4 v[36:39], v30, s[12:15], s60 offen offset:512 sc1
buffer_load_dwordx4 v[40:43], v30, s[12:15], s60 offen offset:1024 sc1
buffer_load_dwordx4 v[44:47], v30, s[12:15], s60 offen offset:1536 sc1
s_waitcnt vmcnt(4)
v_xor_b32 v15, s17, v64
v_bitop3_b32 v15, v66, s17, v15 bitop3:0xbe
v_bitop3_b32 v15, v68, s17, v15 bitop3:0xbe
v_bitop3_b32 v15, v70, s17, v15 bitop3:0xbe
v_and_b32 v14, 0xff, v15
v_xor_b32 v15, s18, v65
v_bitop3_b32 v15, v67, s18, v15 bitop3:0xbe
v_bitop3_b32 v15, v69, s18, v15 bitop3:0xbe
v_bitop3_b32 v15, v71, s18, v15 bitop3:0xbe
v_and_b32 v15, 0xff, v15
v_or_b32 v14, v14, v15
v_and_b32 v64, v19, v64
v_and_b32 v65, v19, v65
v_and_b32 v66, v19, v66
v_and_b32 v67, v19, v67
v_and_b32 v68, v19, v68
v_and_b32 v69, v19, v69
v_and_b32 v70, v19, v70
v_and_b32 v71, v19, v71
v_max3_f32 v72, v64, v66, v68
v_max_f32 v72, v72, v70
v_mov_b32 v74, v72
s_nop 1
v_permlane16_swap_b32 v72, v74
v_max_f32 v72, v72, v74
v_mov_b32 v74, v72
s_nop 1
v_permlane32_swap_b32 v72, v74
v_max_f32 v72, v72, v74
v_sub_f32 v64, v64, v72
v_sub_f32 v66, v66, v72
v_sub_f32 v68, v68, v72
v_sub_f32 v70, v70, v72
v_exp_f32 v64, v64
v_exp_f32 v66, v66
v_exp_f32 v68, v68
v_exp_f32 v70, v70
v_mul_f32 v73, v64, v65
v_fmac_f32 v73, v66, v67
v_fmac_f32 v73, v68, v69
v_fmac_f32 v73, v70, v71
v_cvt_pk_bf16_f32 v65, v64, v64
v_cvt_pk_bf16_f32 v67, v66, v66
v_cvt_pk_bf16_f32 v69, v68, v68
v_cvt_pk_bf16_f32 v71, v70, v70
v_lshlrev_b32 v65, 16, v65
v_lshlrev_b32 v67, 16, v67
v_lshlrev_b32 v69, 16, v69
v_lshlrev_b32 v71, 16, v71
v_sub_f32 v65, v64, v65
v_sub_f32 v67, v66, v67
v_sub_f32 v69, v68, v69
v_sub_f32 v71, v70, v71
v_cvt_pk_bf16_f32 v64, v64, v65
v_cvt_pk_bf16_f32 v66, v66, v67
v_cvt_pk_bf16_f32 v68, v68, v69
v_cvt_pk_bf16_f32 v70, v70, v71
v_mov_b32 v74, v73
s_nop 1
v_permlane16_swap_b32 v73, v74
v_add_f32 v73, v73, v74
v_mov_b32 v74, v73
s_nop 1
v_permlane32_swap_b32 v73, v74
v_add_f32 v73, v73, v74
v_perm_b32 v88, v64, v64, v80
v_perm_b32 v89, v64, v64, v81
v_perm_b32 v90, v64, v64, v82
v_perm_b32 v91, v64, v64, v83
v_perm_b32 v92, v66, v66, v80
v_perm_b32 v93, v66, v66, v81
v_perm_b32 v94, v66, v66, v82
v_perm_b32 v95, v66, v66, v83
v_perm_b32 v96, v68, v68, v80
v_perm_b32 v97, v68, v68, v81
v_perm_b32 v98, v68, v68, v82
v_perm_b32 v99, v68, v68, v83
v_perm_b32 v100, v70, v70, v80
v_perm_b32 v101, v70, v70, v81
v_perm_b32 v102, v70, v70, v82
v_perm_b32 v103, v70, v70, v83
s_waitcnt vmcnt(0)
v_xor_b32 v32, v108, v32
v_xor_b32 v33, v109, v33
v_xor_b32 v34, v110, v34
v_xor_b32 v35, v111, v35
v_xor_b32 v36, v108, v36
v_xor_b32 v37, v109, v37
v_xor_b32 v38, v110, v38
v_xor_b32 v39, v111, v39
v_xor_b32 v40, v108, v40
v_xor_b32 v41, v109, v41
v_xor_b32 v42, v110, v42
v_xor_b32 v43, v111, v43
v_xor_b32 v44, v108, v44
v_xor_b32 v45, v109, v45
v_xor_b32 v46, v110, v46
v_xor_b32 v47, v111, v47
v_mfma_f32_16x16x32_bf16 v[104:107], v[32:35], v[88:91], 0
v_mfma_f32_16x16x32_bf16 v[104:107], v[36:39], v[92:95], v[104:107]
v_mfma_f32_16x16x32_bf16 v[104:107], v[40:43], v[96:99], v[104:107]
v_mfma_f32_16x16x32_bf16 v[104:107], v[44:47], v[100:103], v[104:107]
v_or_b32 v15, v32, v33
v_or3_b32 v15, v34, v35, v15
v_or3_b32 v15, v36, v37, v15
v_or3_b32 v15, v38, v39, v15
v_or3_b32 v15, v40, v41, v15
v_or3_b32 v15, v42, v43, v15
v_or3_b32 v15, v44, v45, v15
v_or3_b32 v15, v46, v47, v15
v_and_b32 v15, 0x00010001, v15
v_or_b32 v14, v14, v15
v_cmp_ne_u32 vcc, 0, v14
s_nop 4
s_cbranch_vccz G4E_23
s_sub_u32 s36, s36, 1
s_cbranch_scc0 G4_22
G4E_23:
ds_write_b128 v85, v[104:107]
s_mov_b64 exec, 1
ds_write_b64 v84, v[72:73]
s_mov_b64 exec, -1
s_waitcnt lgkmcnt(0)
s_mov_b64 exec, 1
ds_add_u32 v2, v3 offset:0
s_mov_b64 exec, -1
s_mov_b32 s33, 200000
LW_24:
ds_read_b32 v13, v2 offset:0
s_sub_u32 s33, s33, 1
s_cbranch_scc1 LE_25
s_waitcnt lgkmcnt(0)
v_readfirstlane_b32 s32, v13
s_nop 0
s_cmp_ge_u32 s32, 4
s_cbranch_scc0 LW_24
LE_25:
s_waitcnt lgkmcnt(0)
ds_read_b128 v[64:67], v31
ds_read_b128 v[68:71], v31 offset:16
ds_read_b128 v[96:99], v86 offset:0
ds_read_b128 v[100:103], v86 offset:128
ds_read_b128 v[104:107], v86 offset:1024
ds_read_b128 v[108:111], v86 offset:1152
ds_read_b128 v[112:115], v86 offset:2048
ds_read_b128 v[116:119], v86 offset:2176
ds_read_b128 v[120:123], v86 offset:3072
ds_read_b128 v[124:127], v86 offset:3200
ds_read_b128 v[128:131], v86 offset:64
ds_read_b128 v[132:135], v86 offset:192
ds_read_b128 v[136:139], v86 offset:1088
ds_read_b128 v[140:143], v86 offset:1216
ds_read_b128 v[144:147], v86 offset:2112
ds_read_b128 v[148:151], v86 offset:2240
ds_read_b128 v[152:155], v86 offset:3136
ds_read_b128 v[156:159], v86 offset:3264
s_waitcnt lgkmcnt(15)
v_max3_f32 v72, v64, v66, v68
v_max_f32 v72, v72, v70
v_sub_f32 v64, v64, v72
v_sub_f32 v66, v66, v72
v_sub_f32 v68, v68, v72
v_sub_f32 v70, v70, v72
v_exp_f32 v64, v64
v_exp_f32 v66, v66
v_exp_f32 v68, v68
v_exp_f32 v70, v70
v_mul_f32 v73, v64, v65
v_fmac_f32 v73, v66, v67
v_fmac_f32 v73, v68, v69
v_fmac_f32 v73, v70, v71
v_rcp_f32 v73, v73
s_nop 0
v_mul_f32 v64, v64, v73
v_mul_f32 v66, v66, v73
v_mul_f32 v68, v68, v73
v_mul_f32 v70, v70, v73
s_waitcnt lgkmcnt(8)
v_add_f32 v96, v96, v100
v_add_f32 v97, v97, v101
v_add_f32 v98, v98, v102
v_add_f32 v99, v99, v103
v_add_f32 v104, v104, v108
v_add_f32 v105, v105, v109
v_add_f32 v106, v106, v110
v_add_f32 v107, v107, v111
v_add_f32 v112, v112, v116
v_add_f32 v113, v113, v117
v_add_f32 v114, v114, v118
v_add_f32 v115, v115, v119
v_add_f32 v120, v120, v124
v_add_f32 v121, v121, v125
v_add_f32 v122, v122, v126
v_add_f32 v123, v123, v127
v_mul_f32 v96, v64, v96
v_mul_f32 v97, v64, v97
v_mul_f32 v98, v64, v98
v_mul_f32 v99, v64, v99
v_fmac_f32 v96, v66, v104
v_fmac_f32 v97, v66, v105
v_fmac_f32 v98, v66, v106
v_fmac_f32 v99, v66, v107
v_fmac_f32 v96, v68, v112
v_fmac_f32 v97, v68, v113
v_fmac_f32 v98, v68, v114
v_fmac_f32 v99, v68, v115
v_fmac_f32 v96, v70, v120
v_fmac_f32 v97, v70, v121
v_fmac_f32 v98, v70, v122
v_fmac_f32 v99, v70, v123
v_cvt_pk_bf16_f32 v76, v96, v97
v_cvt_pk_bf16_f32 v77, v98, v99
v_perm_b32 v32, v76, v76, v4
v_perm_b32 v33, v76, v76, v5
v_perm_b32 v34, v76, v76, v6
v_perm_b32 v35, v76, v76, v7
v_perm_b32 v36, v76, v76, v8
v_perm_b32 v37, v76, v76, v9
v_perm_b32 v38, v76, v76, v10
v_perm_b32 v39, v76, v76, v11
v_perm_b32 v40, v77, v77, v4
v_perm_b32 v41, v77, v77, v5
v_perm_b32 v42, v77, v77, v6
v_perm_b32 v43, v77, v77, v7
v_perm_b32 v44, v77, v77, v8
v_perm_b32 v45, v77, v77, v9
v_perm_b32 v46, v77, v77, v10
v_perm_b32 v47, v77, v77, v11
v_mfma_f32_16x16x32_bf16 v[72:75], v[160:163], v[32:35], 0
v_mfma_f32_16x16x32_bf16 v[72:75], v[164:167], v[36:39], v[72:75]
v_mfma_f32_16x16x32_bf16 v[72:75], v[168:171], v[40:43], v[72:75]
v_mfma_f32_16x16x32_bf16 v[72:75], v[172:175], v[44:47], v[72:75]
s_waitcnt lgkmcnt(0)
v_add_f32 v128, v128, v132
v_add_f32 v129, v129, v133
v_add_f32 v130, v130, v134
v_add_f32 v131, v131, v135
v_add_f32 v136, v136, v140
v_add_f32 v137, v137, v141
v_add_f32 v138, v138, v142
v_add_f32 v139, v139, v143
v_add_f32 v144, v144, v148
v_add_f32 v145, v145, v149
v_add_f32 v146, v146, v150
v_add_f32 v147, v147, v151
v_add_f32 v152, v152, v156
v_add_f32 v153, v153, v157
v_add_f32 v154, v154, v158
v_add_f32 v155, v155, v159
v_mul_f32 v128, v64, v128
v_mul_f32 v129, v64, v129
v_mul_f32 v130, v64, v130
v_mul_f32 v131, v64, v131
v_fmac_f32 v128, v66, v136
v_fmac_f32 v129, v66, v137
v_fmac_f32 v130, v66, v138
v_fmac_f32 v131, v66, v139
v_fmac_f32 v128, v68, v144
v_fmac_f32 v129, v68, v145
v_fmac_f32 v130, v68, v146
v_fmac_f32 v131, v68, v147
v_fmac_f32 v128, v70, v152
v_fmac_f32 v129, v70, v153
v_fmac_f32 v130, v70, v154
v_fmac_f32 v131, v70, v155
v_cvt_pk_bf16_f32 v78, v128, v129
v_cvt_pk_bf16_f32 v79, v130, v131
v_perm_b32 v48, v78, v78, v4
v_perm_b32 v49, v78, v78, v5
v_perm_b32 v50, v78, v78, v6
v_perm_b32 v51, v78, v78, v7
v_perm_b32 v52, v78, v78, v8
v_perm_b32 v53, v78, v78, v9
v_perm_b32 v54, v78, v78, v10
v_perm_b32 v55, v78, v78, v11
v_perm_b32 v56, v79, v79, v4
v_perm_b32 v57, v79, v79, v5
v_perm_b32 v58, v79, v79, v6
v_perm_b32 v59, v79, v79, v7
v_perm_b32 v60, v79, v79, v8
v_perm_b32 v61, v79, v79, v9
v_perm_b32 v62, v79, v79, v10
v_perm_b32 v63, v79, v79, v11
v_mfma_f32_16x16x32_bf16 v[72:75], v[176:179], v[48:51], v[72:75]
v_mfma_f32_16x16x32_bf16 v[72:75], v[180:183], v[52:55], v[72:75]
v_mfma_f32_16x16x32_bf16 v[72:75], v[184:187], v[56:59], v[72:75]
v_mfma_f32_16x16x32_bf16 v[72:75], v[188:191], v[60:63], v[72:75]
s_nop 7
ds_write_b128 v87, v[72:75]
s_waitcnt lgkmcnt(0)
s_mov_b64 exec, 1
ds_add_u32 v2, v3 offset:0
s_mov_b64 exec, -1
v_and_b32 v89, 15, v1
v_lshlrev_b32 v89, 1, v89
v_lshrrev_b32 v89, v89, s16
v_bfe_u32 v90, v89, 1, 1
v_bfe_u32 v88, v89, 0, 1
v_lshl_or_b32 v88, v90, 16, v88
s_cmp_lg_u32 s3, 0
s_cbranch_scc1 C_H5
v_lshrrev_b32 v30, 4, v1
v_lshlrev_b32 v30, 8, v30
v_and_b32 v31, 15, v1
v_lshl_add_u32 v30, v31, 3, v30
v_add_u32 v30, 131072, v30
v_lshrrev_b32 v29, 5, v1
v_lshlrev_b32 v28, 10, v29
v_and_b32 v31, 31, v1
v_lshl_add_u32 v31, v31, 2, v28
v_lshlrev_b32 v29, 8, v1
v_mov_b32 v28, s16
s_lshr_b32 s34, s2, 3
s_lshl_b32 s35, s34, 11
s_and_b32 s28, s2, 7
s_lshl_b32 s29, s28, 7
s_add_u32 s35, s35, s29
s_add_u32 s35, s35, 327680
s_lshl_b32 s34, s34, 9
s_lshr_b32 s29, s28, 1
s_lshl_b32 s29, s29, 6
s_add_u32 s34, s34, s29
s_and_b32 s29, s28, 1
s_lshl_b32 s29, s29, 2
s_add_u32 s34, s34, s29
s_add_u32 s34, s34, 393216
s_mov_b32 s33, 200000
LW_26:
ds_read_b32 v13, v2 offset:0
s_sub_u32 s33, s33, 1
s_cbranch_scc1 LE_27
s_waitcnt lgkmcnt(0)
v_readfirstlane_b32 s32, v13
s_nop 0
s_cmp_ge_u32 s32, 8
s_cbranch_scc0 LW_26
LE_27:
s_waitcnt lgkmcnt(0)
ds_read_b64 v[20:21], v30 offset:0
ds_read_b64 v[22:23], v30 offset:1024
ds_read_b64 v[24:25], v30 offset:2048
ds_read_b64 v[26:27], v30 offset:3072
s_waitcnt lgkmcnt(0)
v_add_f32 v20, v20, v22
v_add_f32 v24, v24, v26
v_add_f32 v20, v20, v24
v_add_f32 v21, v21, v23
v_add_f32 v25, v25, v27
v_add_f32 v21, v21, v25
v_perm_b32 v22, v21, v20, v16
v_add_u32 v22, 0x00010001, v22
v_and_or_b32 v22, v22, v17, v88
buffer_store_dword v22, v31, s[12:15], s35 offen sc1
s_mov_b64 exec, 3
buffer_store_dword v28, v29, s[12:15], s34 offen sc1
s_mov_b64 exec, -1
C_H5:
s_lshr_b32 s35, s2, 2
s_lshl_b32 s34, s35, 10
s_lshl_b32 s28, s3, 8
s_add_u32 s34, s34, s28
s_lshl_b32 s35, s35, 8
s_lshl_b32 s28, s3, 6
s_add_u32 s35, s35, s28
v_mov_b32 v20, 0
s_mov_b32 s33, 25000
C_p5:
s_load_dwordx16 s[36:51], s[12:13], s34 offset:327680 glc
s_load_dwordx16 s[52:67], s[12:13], s34 offset:327744 glc
s_load_dwordx16 s[68:83], s[12:13], s34 offset:327808 glc
s_load_dwordx16 s[84:99], s[12:13], s34 offset:327872 glc
s_load_dwordx2 s[24:25], s[12:13], s35 offset:393216 glc
s_sub_u32 s33, s33, 1
s_cbranch_scc1 C_e5
s_waitcnt lgkmcnt(0)
s_cmp_lg_u32 s24, s16
s_cbranch_scc1 C_p5
s_cmp_lg_u32 s25, s16
s_cbranch_scc1 C_p5
v_writelane_b32 v20, s36, 0
v_writelane_b32 v20, s37, 1
v_writelane_b32 v20, s38, 2
v_writelane_b32 v20, s39, 3
v_writelane_b32 v20, s40, 4
v_writelane_b32 v20, s41, 5
v_writelane_b32 v20, s42, 6
v_writelane_b32 v20, s43, 7
v_writelane_b32 v20, s44, 8
v_writelane_b32 v20, s45, 9
v_writelane_b32 v20, s46, 10
v_writelane_b32 v20, s47, 11
v_writelane_b32 v20, s48, 12
v_writelane_b32 v20, s49, 13
v_writelane_b32 v20, s50, 14
v_writelane_b32 v20, s51, 15
v_writelane_b32 v20, s52, 16
v_writelane_b32 v20, s53, 17
v_writelane_b32 v20, s54, 18
v_writelane_b32 v20, s55, 19
v_writelane_b32 v20, s56, 20
v_writelane_b32 v20, s57, 21
v_writelane_b32 v20, s58, 22
v_writelane_b32 v20, s59, 23
v_writelane_b32 v20, s60, 24
v_writelane_b32 v20, s61, 25
v_writelane_b32 v20, s62, 26
v_writelane_b32 v20, s63, 27
v_writelane_b32 v20, s64, 28
v_writelane_b32 v20, s65, 29
v_writelane_b32 v20, s66, 30
v_writelane_b32 v20, s67, 31
v_writelane_b32 v20, s68, 32
v_writelane_b32 v20, s69, 33
v_writelane_b32 v20, s70, 34
v_writelane_b32 v20, s71, 35
v_writelane_b32 v20, s72, 36
v_writelane_b32 v20, s73, 37
v_writelane_b32 v20, s74, 38
v_writelane_b32 v20, s75, 39
v_writelane_b32 v20, s76, 40
v_writelane_b32 v20, s77, 41
v_writelane_b32 v20, s78, 42
v_writelane_b32 v20, s79, 43
v_writelane_b32 v20, s80, 44
v_writelane_b32 v20, s81, 45
v_writelane_b32 v20, s82, 46
v_writelane_b32 v20, s83, 47
v_writelane_b32 v20, s84, 48
v_writelane_b32 v20, s85, 49
v_writelane_b32 v20, s86, 50
v_writelane_b32 v20, s87, 51
v_writelane_b32 v20, s88, 52
v_writelane_b32 v20, s89, 53
v_writelane_b32 v20, s90, 54
v_writelane_b32 v20, s91, 55
v_writelane_b32 v20, s92, 56
v_writelane_b32 v20, s93, 57
v_writelane_b32 v20, s94, 58
v_writelane_b32 v20, s95, 59
v_writelane_b32 v20, s96, 60
v_writelane_b32 v20, s97, 61
v_writelane_b32 v20, s98, 62
v_writelane_b32 v20, s99, 63
v_xor_b32 v20, v88, v20
v_and_b32 v14, 0x00010001, v20
v_cmp_ne_u32 vcc, 0, v14
s_nop 4
s_cbranch_vccnz C_p5
C_e5:
s_waitcnt lgkmcnt(0)
s_lshl_b32 s28, s3, 8
s_add_u32 s28, s28, 155648
v_lshl_add_u32 v21, v1, 2, s28
ds_write_b32 v21, v20
s_waitcnt lgkmcnt(0)
s_mov_b64 exec, 1
ds_add_u32 v2, v3 offset:56
s_mov_b64 exec, -1
s_cmp_lg_u32 s3, 1
s_cbranch_scc1 L_end
v_bfe_u32 v100, s16, 0, 8
v_bfe_u32 v101, s16, 8, 8
v_bfe_u32 v102, s16, 16, 8
v_bfe_u32 v103, s16, 24, 8
v_and_b32 v21, 31, v1
v_lshlrev_b32 v21, 2, v21
v_add_u32 v21, 155648, v21
v_lshrrev_b32 v22, 4, v1
v_lshlrev_b32 v22, 5, v22
v_add_u32 v22, 156672, v22
s_mov_b32 s33, 200000
LW_28:
ds_read_b32 v13, v2 offset:56
s_sub_u32 s33, s33, 1
s_cbranch_scc1 LE_29
s_waitcnt lgkmcnt(0)
v_readfirstlane_b32 s32, v13
s_nop 0
s_cmp_ge_u32 s32, 4
s_cbranch_scc0 LW_28
LE_29:
s_waitcnt lgkmcnt(0)
ds_read_b32 v32, v21 offset:0
ds_read_b32 v33, v21 offset:128
ds_read_b32 v34, v21 offset:256
ds_read_b32 v35, v21 offset:384
ds_read_b32 v36, v21 offset:512
ds_read_b32 v37, v21 offset:640
ds_read_b32 v38, v21 offset:768
ds_read_b32 v39, v21 offset:896
s_waitcnt lgkmcnt(0)
v_lshlrev_b32 v40, 16, v32
v_and_b32 v32, 0xffff0000, v32
v_lshlrev_b32 v41, 16, v33
v_and_b32 v33, 0xffff0000, v33
v_lshlrev_b32 v42, 16, v34
v_and_b32 v34, 0xffff0000, v34
v_lshlrev_b32 v43, 16, v35
v_and_b32 v35, 0xffff0000, v35
v_lshlrev_b32 v44, 16, v36
v_and_b32 v36, 0xffff0000, v36
v_lshlrev_b32 v45, 16, v37
v_and_b32 v37, 0xffff0000, v37
v_lshlrev_b32 v46, 16, v38
v_and_b32 v38, 0xffff0000, v38
v_lshlrev_b32 v47, 16, v39
v_and_b32 v39, 0xffff0000, v39
v_add_f32 v40, v40, v44
v_add_f32 v32, v32, v36
v_add_f32 v41, v41, v45
v_add_f32 v33, v33, v37
v_add_f32 v42, v42, v46
v_add_f32 v34, v34, v38
v_add_f32 v43, v43, v47
v_add_f32 v35, v35, v39
v_add_f32 v40, v40, v42
v_add_f32 v32, v32, v34
v_add_f32 v41, v41, v43
v_add_f32 v33, v33, v35
v_add_f32 v40, v40, v41
v_add_f32 v32, v32, v33
v_mov_b32 v28, v40
v_mov_b32 v24, v32
v_cvt_pk_bf16_f32 v24, v28, v24
ds_write_b32 v21, v24 offset:1024
s_waitcnt lgkmcnt(0)
ds_read_b128 v[24:27], v22
ds_read_b128 v[28:31], v22 offset:16
s_waitcnt lgkmcnt(0)
v_perm_b32 v32, v24, v24, v4
v_perm_b32 v33, v24, v24, v5
v_perm_b32 v34, v24, v24, v6
v_perm_b32 v35, v24, v24, v7
v_perm_b32 v36, v24, v24, v8
v_perm_b32 v37, v24, v24, v9
v_perm_b32 v38, v24, v24, v10
v_perm_b32 v39, v24, v24, v11
v_perm_b32 v40, v25, v25, v4
v_perm_b32 v41, v25, v25, v5
v_perm_b32 v42, v25, v25, v6
v_perm_b32 v43, v25, v25, v7
v_perm_b32 v44, v25, v25, v8
v_perm_b32 v45, v25, v25, v9
v_perm_b32 v46, v25, v25, v10
v_perm_b32 v47, v25, v25, v11
v_perm_b32 v48, v26, v26, v4
v_perm_b32 v49, v26, v26, v5
v_perm_b32 v50, v26, v26, v6
v_perm_b32 v51, v26, v26, v7
v_perm_b32 v52, v26, v26, v8
v_perm_b32 v53, v26, v26, v9
v_perm_b32 v54, v26, v26, v10
v_perm_b32 v55, v26, v26, v11
v_perm_b32 v56, v27, v27, v4
v_perm_b32 v57, v27, v27, v5
v_perm_b32 v58, v27, v27, v6
v_perm_b32 v59, v27, v27, v7
v_perm_b32 v60, v27, v27, v8
v_perm_b32 v61, v27, v27, v9
v_perm_b32 v62, v27, v27, v10
v_perm_b32 v63, v27, v27, v11
v_perm_b32 v64, v28, v28, v4
v_perm_b32 v65, v28, v28, v5
v_perm_b32 v66, v28, v28, v6
v_perm_b32 v67, v28, v28, v7
v_perm_b32 v68, v28, v28, v8
v_perm_b32 v69, v28, v28, v9
v_perm_b32 v70, v28, v28, v10
v_perm_b32 v71, v28, v28, v11
v_perm_b32 v72, v29, v29, v4
v_perm_b32 v73, v29, v29, v5
v_perm_b32 v74, v29, v29, v6
v_perm_b32 v75, v29, v29, v7
v_perm_b32 v76, v29, v29, v8
v_perm_b32 v77, v29, v29, v9
v_perm_b32 v78, v29, v29, v10
v_perm_b32 v79, v29, v29, v11
v_perm_b32 v80, v30, v30, v4
v_perm_b32 v81, v30, v30, v5
v_perm_b32 v82, v30, v30, v6
v_perm_b32 v83, v30, v30, v7
v_perm_b32 v84, v30, v30, v8
v_perm_b32 v85, v30, v30, v9
v_perm_b32 v86, v30, v30, v10
v_perm_b32 v87, v30, v30, v11
v_perm_b32 v88, v31, v31, v4
v_perm_b32 v89, v31, v31, v5
v_perm_b32 v90, v31, v31, v6
v_perm_b32 v91, v31, v31, v7
v_perm_b32 v92, v31, v31, v8
v_perm_b32 v93, v31, v31, v9
v_perm_b32 v94, v31, v31, v10
v_perm_b32 v95, v31, v31, v11
v_lshlrev_b32 v23, 4, v1
v_add_u32 v23, 114688, v23
s_mov_b32 s33, 200000
LW_30:
ds_read_b32 v13, v2 offset:40
s_sub_u32 s33, s33, 1
s_cbranch_scc1 LE_31
s_waitcnt lgkmcnt(0)
v_readfirstlane_b32 s32, v13
s_nop 0
s_cmp_ge_u32 s32, 1
s_cbranch_scc1 LE_31
s_sleep 1
s_branch LW_30
LE_31:
s_waitcnt lgkmcnt(0)
ds_read_b128 v[192:195], v23 offset:0
ds_read_b128 v[196:199], v23 offset:1024
ds_read_b128 v[200:203], v23 offset:2048
ds_read_b128 v[204:207], v23 offset:3072
ds_read_b128 v[208:211], v23 offset:4096
ds_read_b128 v[212:215], v23 offset:5120
ds_read_b128 v[216:219], v23 offset:6144
ds_read_b128 v[220:223], v23 offset:7168
ds_read_b128 v[224:227], v23 offset:8192
ds_read_b128 v[228:231], v23 offset:9216
ds_read_b128 v[232:235], v23 offset:10240
ds_read_b128 v[236:239], v23 offset:11264
ds_read_b128 v[240:243], v23 offset:12288
ds_read_b128 v[244:247], v23 offset:13312
ds_read_b128 v[248:251], v23 offset:14336
ds_read_b128 v[252:255], v23 offset:15360
s_waitcnt lgkmcnt(15)
v_mfma_f32_16x16x32_bf16 v[96:99], v[192:195], v[32:35], 0
s_waitcnt lgkmcnt(14)
v_mfma_f32_16x16x32_bf16 v[96:99], v[196:199], v[36:39], v[96:99]
s_waitcnt lgkmcnt(13)
v_mfma_f32_16x16x32_bf16 v[96:99], v[200:203], v[40:43], v[96:99]
s_waitcnt lgkmcnt(12)
v_mfma_f32_16x16x32_bf16 v[96:99], v[204:207], v[44:47], v[96:99]
s_waitcnt lgkmcnt(11)
v_mfma_f32_16x16x32_bf16 v[96:99], v[208:211], v[48:51], v[96:99]
s_waitcnt lgkmcnt(10)
v_mfma_f32_16x16x32_bf16 v[96:99], v[212:215], v[52:55], v[96:99]
s_waitcnt lgkmcnt(9)
v_mfma_f32_16x16x32_bf16 v[96:99], v[216:219], v[56:59], v[96:99]
s_waitcnt lgkmcnt(8)
v_mfma_f32_16x16x32_bf16 v[96:99], v[220:223], v[60:63], v[96:99]
s_waitcnt lgkmcnt(7)
v_mfma_f32_16x16x32_bf16 v[96:99], v[224:227], v[64:67], v[96:99]
s_waitcnt lgkmcnt(6)
v_mfma_f32_16x16x32_bf16 v[96:99], v[228:231], v[68:71], v[96:99]
s_waitcnt lgkmcnt(5)
v_mfma_f32_16x16x32_bf16 v[96:99], v[232:235], v[72:75], v[96:99]
s_waitcnt lgkmcnt(4)
v_mfma_f32_16x16x32_bf16 v[96:99], v[236:239], v[76:79], v[96:99]
s_waitcnt lgkmcnt(3)
v_mfma_f32_16x16x32_bf16 v[96:99], v[240:243], v[80:83], v[96:99]
s_waitcnt lgkmcnt(2)
v_mfma_f32_16x16x32_bf16 v[96:99], v[244:247], v[84:87], v[96:99]
s_waitcnt lgkmcnt(1)
v_mfma_f32_16x16x32_bf16 v[96:99], v[248:251], v[88:91], v[96:99]
s_waitcnt lgkmcnt(0)
v_mfma_f32_16x16x32_bf16 v[96:99], v[252:255], v[92:95], v[96:99]
s_lshr_b32 s34, s2, 2
s_and_b32 s35, s2, 3
s_nop 5
v_and_or_b32 v20, v96, v19, v100
v_and_or_b32 v21, v97, v19, v101
v_and_or_b32 v22, v98, v19, v102
v_and_or_b32 v23, v99, v19, v103
v_lshrrev_b32 v24, 4, v1
v_lshlrev_b32 v24, 7, v24
v_and_b32 v25, 7, v1
v_lshl_add_u32 v24, v25, 4, v24
s_lshl_b32 s28, s34, 11
s_lshl_b32 s29, s35, 9
s_add_u32 s28, s28, s29
s_add_u32 s28, s28, 851968
s_mov_b32 exec_lo, 0x00ff00ff
s_cmp_eq_u32 s35, 3
s_cselect_b32 exec_hi, 0, 0x00ff00ff
buffer_store_dwordx4 v[20:23], v24, s[12:15], s28 offen sc1
s_mov_b64 exec, -1
s_cmp_lt_u32 s2, 128
s_cbranch_scc1 C_1end
s_and_b32 s34, s2, 7
s_lshl_b32 s34, s34, 3
s_and_b32 s28, s2, 64
s_add_u32 s34, s34, s28
s_bfe_u32 s28, s2, 0x30003
s_add_u32 s34, s34, s28
s_cmp_ge_u32 s34, 112
s_cbranch_scc1 C_1end
v_lshlrev_b32 v28, 11, v1
s_lshl_b32 s4, s34, 4
s_add_u32 s4, s4, 851968
v_lshrrev_b32 v29, 4, v1
v_lshlrev_b32 v30, 1, v29
v_and_b32 v30, 2, v30
v_lshrrev_b32 v29, 1, v29
v_or_b32 v29, v29, v30
v_lshlrev_b32 v29, 4, v29
s_lshr_b32 s5, s34, 3
s_lshl_b32 s5, s5, 5
s_and_b32 s29, s34, 7
s_add_u32 s5, s5, s29
s_lshl_b32 s5, s5, 1
s_add_u32 s5, s5, 896
s_and_b32 s6, s34, 7
s_lshl_b32 s6, s6, 10
s_lshr_b32 s28, s34, 5
s_lshl_b32 s28, s28, 8
s_add_u32 s6, s6, s28
s_mov_b32 s8, s26
s_mov_b32 s9, s27
s_mov_b32 s10, 1792
s_mov_b32 s11, 0x00020000
s_mov_b32 s33, 25000
s_waitcnt vmcnt(0)
RO_32:
buffer_load_dwordx4 v[20:23], v28, s[12:15], s4 offen sc1
s_sub_u32 s33, s33, 1
s_cbranch_scc1 RE_33
s_waitcnt vmcnt(0)
v_xor_b32 v15, v100, v20
v_bitop3_b32 v15, v21, v101, v15 bitop3:0xbe
v_bitop3_b32 v15, v22, v102, v15 bitop3:0xbe
v_bitop3_b32 v15, v23, v103, v15 bitop3:0xbe
v_and_b32 v14, 0xff, v15
v_cmp_ne_u32 vcc, 0, v14
v_and_b32 v20, v19, v20
v_and_b32 v21, v19, v21
v_and_b32 v22, v19, v22
v_and_b32 v23, v19, v23
s_nop 0
s_cbranch_vccnz RO_32
RE_33:
s_waitcnt vmcnt(0)
v_permlane32_swap_b32 v20, v21
v_permlane32_swap_b32 v22, v23
v_add_f32 v20, v20, v21
v_add_f32 v22, v22, v23
s_nop 1
v_permlane16_swap_b32 v20, v22
v_add_f32 v20, v20, v22
s_nop 1
v_add_f32 v20, v20, v20 row_ror:8 row_mask:0xf bank_mask:0xf
s_nop 1
v_add_f32 v20, v20, v20 row_ror:4 row_mask:0xf bank_mask:0xf
s_nop 1
v_add_f32 v20, v20, v20 row_ror:2 row_mask:0xf bank_mask:0xf
s_nop 1
v_add_f32 v20, v20, v20 row_ror:1 row_mask:0xf bank_mask:0xf
v_cvt_pk_bf16_f32 v20, v20, v20
s_mov_b32 exec_lo, 0x00010001
s_mov_b32 exec_hi, 0x00010001
buffer_store_short v20, v29, s[8:11], s5 offen
s_mov_b64 exec, -1
C_1end:
s_endpgm
L_S:
v_mov_b32 v12, 0
v_mov_b32 v2, 163072
v_mov_b32 v3, 1
s_bfe_u32 s101, s2, 0x20003
s_and_b32 s28, s2, 7
s_and_b32 s31, s2, 0xc0
s_lshl_b32 s28, s28, 3
s_add_u32 s31, s31, s28
s_bfe_u32 s28, s2, 0x30003
s_add_u32 s31, s31, s28
v_mov_b32 v0, s31
v_mov_b32 v13, 0
v_lshl_add_u32 v14, v1, 2, v2
s_mov_b32 exec_hi, 0
ds_write_b32 v14, v13
s_mov_b64 exec, -1
v_lshlrev_b32 v18, 4, v1
s_waitcnt lgkmcnt(0)
s_mov_b32 s12, s62
s_mov_b32 s13, s63
s_mov_b32 s14, 3407872
s_mov_b32 s15, 0x00020000
s_load_dword s16, s[12:13], 0
s_mov_b64 s[26:27], s[58:59]
s_mov_b64 s[20:21], s[38:39]
s_mov_b64 s[22:23], s[40:41]
s_mov_b64 s[24:25], s[44:45]
s_barrier
v_and_b32 v13, 1, v1
v_cmp_eq_u32 vcc, 1, v13
v_mov_b32 v14, 0x0c0c0100
v_mov_b32 v15, 0x01000c0c
v_cndmask_b32 v14, v14, v15, vcc
v_mov_b32 v31, 0x0c0c0302
v_mov_b32 v15, 0x03020c0c
v_cndmask_b32 v15, v31, v15, vcc
v_bfe_u32 v13, v1, 1, 2
v_mov_b32 v31, 0x0c0c0c0c
v_cmp_eq_u32 vcc, 0, v13
s_nop 1
v_cndmask_b32 v4, v31, v14, vcc
v_cndmask_b32 v8, v31, v15, vcc
v_cmp_eq_u32 vcc, 1, v13
s_nop 1
v_cndmask_b32 v5, v31, v14, vcc
v_cndmask_b32 v9, v31, v15, vcc
v_cmp_eq_u32 vcc, 2, v13
s_nop 1
v_cndmask_b32 v6, v31, v14, vcc
v_cndmask_b32 v10, v31, v15, vcc
v_cmp_eq_u32 vcc, 3, v13
s_nop 1
v_cndmask_b32 v7, v31, v14, vcc
v_cndmask_b32 v11, v31, v15, vcc
v_mov_b32 v16, 0x07060302
v_mov_b32 v17, 0xfffefffe
v_mov_b32 v19, 0xffffff00
s_lshl_b32 s34, s3, 9
v_and_b32 v20, 15, v1
v_and_b32 v21, 7, v20
v_lshlrev_b32 v21, 1, v21
v_lshrrev_b32 v22, 3, v20
v_or_b32 v21, v21, v22
v_lshrrev_b32 v22, 4, v1
v_lshlrev_b32 v22, 1, v22
v_xor_b32 v21, v21, v22
v_lshlrev_b32 v21, 4, v21
v_lshl_add_u32 v21, v20, 11, v21
v_add_u32 v21, s34, v21
v_xor_b32 v112, 0, v21
v_add_u32 v116, 0x10000, v112
v_xor_b32 v113, 16, v21
v_add_u32 v117, 0x10000, v113
v_xor_b32 v114, 128, v21
v_add_u32 v118, 0x10000, v114
v_xor_b32 v115, 144, v21
v_add_u32 v119, 0x10000, v115
v_xor_b32 v23, 128, v110
s_add_u32 m0, s65, 8192
s_add_u32 s28, s64, 8192
s_waitcnt vmcnt(7)
buffer_load_dwordx4 v23, s[4:7], s28 offen offset:0 nt lds
s_waitcnt vmcnt(7)
buffer_load_dwordx4 v23, s[4:7], s28 offen offset:1024 nt lds
v_xor_b32 v23, 160, v110
s_add_u32 m0, s65, 10240
s_add_u32 s28, s64, 10240
s_waitcnt vmcnt(7)
buffer_load_dwordx4 v23, s[4:7], s28 offen offset:0 nt lds
s_waitcnt vmcnt(7)
buffer_load_dwordx4 v23, s[4:7], s28 offen offset:1024 nt lds
v_xor_b32 v23, 192, v110
s_add_u32 m0, s65, 12288
s_add_u32 s28, s64, 12288
s_waitcnt vmcnt(7)
buffer_load_dwordx4 v23, s[4:7], s28 offen offset:0 nt lds
s_waitcnt vmcnt(7)
buffer_load_dwordx4 v23, s[4:7], s28 offen offset:1024 nt lds
v_xor_b32 v23, 224, v110
s_add_u32 m0, s65, 14336
s_add_u32 s28, s64, 14336
s_waitcnt vmcnt(7)
buffer_load_dwordx4 v23, s[4:7], s28 offen offset:0 nt lds
s_waitcnt vmcnt(7)
buffer_load_dwordx4 v23, s[4:7], s28 offen offset:1024 nt lds
v_xor_b32 v23, 0, v110
s_add_u32 m0, s65, 65536
s_add_u32 s28, s64, 65536
s_waitcnt vmcnt(7)
buffer_load_dwordx4 v23, s[4:7], s28 offen offset:0 nt lds
s_waitcnt vmcnt(7)
buffer_load_dwordx4 v23, s[4:7], s28 offen offset:1024 nt lds
v_xor_b32 v23, 32, v110
s_add_u32 m0, s65, 67584
s_add_u32 s28, s64, 67584
s_waitcnt vmcnt(7)
buffer_load_dwordx4 v23, s[4:7], s28 offen offset:0 nt lds
s_waitcnt vmcnt(7)
buffer_load_dwordx4 v23, s[4:7], s28 offen offset:1024 nt lds
v_xor_b32 v23, 64, v110
s_add_u32 m0, s65, 69632
s_add_u32 s28, s64, 69632
s_waitcnt vmcnt(7)
buffer_load_dwordx4 v23, s[4:7], s28 offen offset:0 nt lds
s_waitcnt vmcnt(7)
buffer_load_dwordx4 v23, s[4:7], s28 offen offset:1024 nt lds
v_xor_b32 v23, 96, v110
s_add_u32 m0, s65, 71680
s_add_u32 s28, s64, 71680
s_waitcnt vmcnt(7)
buffer_load_dwordx4 v23, s[4:7], s28 offen offset:0 nt lds
s_waitcnt vmcnt(7)
s_waitcnt lgkmcnt(0)
s_mov_b64 exec, 1
ds_add_u32 v2, v3 offset:8
s_mov_b64 exec, -1
buffer_load_dwordx4 v23, s[4:7], s28 offen offset:1024 nt lds
v_xor_b32 v23, 128, v110
s_add_u32 m0, s65, 73728
s_add_u32 s28, s64, 73728
s_waitcnt vmcnt(7)
buffer_load_dwordx4 v23, s[4:7], s28 offen offset:0 nt lds
s_waitcnt vmcnt(7)
buffer_load_dwordx4 v23, s[4:7], s28 offen offset:1024 nt lds
s_mov_b32 s33, 200000
LW_34:
ds_read_b32 v13, v2 offset:8
s_sub_u32 s33, s33, 1
s_cbranch_scc1 LE_35
s_waitcnt lgkmcnt(0)
v_readfirstlane_b32 s32, v13
s_nop 0
s_cmp_ge_u32 s32, 4
s_cbranch_scc0 LW_34
LE_35:
s_waitcnt lgkmcnt(0)
ds_read_b128 v[128:131], v112 offset:0
ds_read_b128 v[132:135], v113 offset:0
ds_read_b128 v[136:139], v114 offset:0
ds_read_b128 v[140:143], v115 offset:0
ds_read_b128 v[144:147], v112 offset:256
ds_read_b128 v[148:151], v113 offset:256
ds_read_b128 v[152:155], v114 offset:256
ds_read_b128 v[156:159], v115 offset:256
ds_read_b128 v[160:163], v112 offset:32768
ds_read_b128 v[164:167], v113 offset:32768
ds_read_b128 v[168:171], v114 offset:32768
ds_read_b128 v[172:175], v115 offset:32768
ds_read_b128 v[176:179], v112 offset:33024
ds_read_b128 v[180:183], v113 offset:33024
ds_read_b128 v[184:187], v114 offset:33024
ds_read_b128 v[188:191], v115 offset:33024
s_waitcnt lgkmcnt(0)
s_mov_b64 exec, 1
ds_add_u32 v2, v3 offset:24
s_mov_b64 exec, -1
v_xor_b32 v23, 160, v110
s_add_u32 m0, s65, 75776
s_add_u32 s28, s64, 75776
s_waitcnt vmcnt(7)
buffer_load_dwordx4 v23, s[4:7], s28 offen offset:0 nt lds
s_waitcnt vmcnt(7)
buffer_load_dwordx4 v23, s[4:7], s28 offen offset:1024 nt lds
v_xor_b32 v23, 192, v110
s_add_u32 m0, s65, 77824
s_add_u32 s28, s64, 77824
s_waitcnt vmcnt(7)
buffer_load_dwordx4 v23, s[4:7], s28 offen offset:0 nt lds
s_waitcnt vmcnt(7)
buffer_load_dwordx4 v23, s[4:7], s28 offen offset:1024 nt lds
v_xor_b32 v23, 224, v110
s_add_u32 m0, s65, 79872
s_add_u32 s28, s64, 79872
s_waitcnt vmcnt(7)
buffer_load_dwordx4 v23, s[4:7], s28 offen offset:0 nt lds
s_waitcnt vmcnt(7)
buffer_load_dwordx4 v23, s[4:7], s28 offen offset:1024 nt lds
s_waitcnt vmcnt(0)
s_waitcnt lgkmcnt(0)
s_mov_b64 exec, 1
ds_add_u32 v2, v3 offset:12
s_mov_b64 exec, -1
s_mov_b32 s33, 200000
LW_36:
ds_read_b32 v13, v2 offset:12
s_sub_u32 s33, s33, 1
s_cbranch_scc1 LE_37
s_waitcnt lgkmcnt(0)
v_readfirstlane_b32 s32, v13
s_nop 0
s_cmp_ge_u32 s32, 4
s_cbranch_scc0 LW_36
LE_37:
s_waitcnt lgkmcnt(0)
ds_read_b128 v[192:195], v116 offset:0
ds_read_b128 v[196:199], v117 offset:0
ds_read_b128 v[200:203], v118 offset:0
ds_read_b128 v[204:207], v119 offset:0
ds_read_b128 v[208:211], v116 offset:256
ds_read_b128 v[212:215], v117 offset:256
ds_read_b128 v[216:219], v118 offset:256
ds_read_b128 v[220:223], v119 offset:256
ds_read_b128 v[224:227], v116 offset:32768
ds_read_b128 v[228:231], v117 offset:32768
ds_read_b128 v[232:235], v118 offset:32768
ds_read_b128 v[236:239], v119 offset:32768
ds_read_b128 v[240:243], v116 offset:33024
ds_read_b128 v[244:247], v117 offset:33024
ds_read_b128 v[248:251], v118 offset:33024
ds_read_b128 v[252:255], v119 offset:33024
s_waitcnt lgkmcnt(0)
s_mov_b64 exec, 1
ds_add_u32 v2, v3 offset:28
s_mov_b64 exec, -1
s_waitcnt lgkmcnt(0)
s_add_u32 s16, s16, 0x01010101
s_and_b32 s17, s16, 0xff
s_bfe_u32 s18, s16, 0x80010
v_lshlrev_b32 v24, 4, v1
v_add_u32 v24, 131072, v24
s_mul_i32 s34, s3, 3072
v_add_u32 v25, s34, v24
s_lshl_b32 s34, s3, 10
v_and_b32 v27, 15, v1
v_lshlrev_b32 v27, 5, v27
v_add_u32 v27, 159744, v27
s_lshl_b32 s34, s3, 2
v_add_u32 v28, s34, v27
s_lshl_b32 s34, s3, 9
s_add_u32 s34, s34, 157696
v_lshl_add_u32 v29, v1, 3, s34
v_lshrrev_b32 v30, 4, v1
v_lshlrev_b32 v30, 3, v30
v_lshrrev_b32 v30, v30, s16
v_bfe_u32 v31, v30, 1, 1
v_bfe_u32 v120, v30, 0, 1
v_lshl_or_b32 v120, v31, 16, v120
v_bfe_u32 v31, v30, 3, 1
v_bfe_u32 v121, v30, 2, 1
v_lshl_or_b32 v121, v31, 16, v121
v_bfe_u32 v31, v30, 5, 1
v_bfe_u32 v122, v30, 4, 1
v_lshl_or_b32 v122, v31, 16, v122
v_bfe_u32 v31, v30, 7, 1
v_bfe_u32 v123, v30, 6, 1
v_lshl_or_b32 v123, v31, 16, v123
s_setprio 3
s_and_b32 s34, s2, 7
s_lshl_b32 s34, s34, 8
s_lshl_b32 s35, s3, 6
s_add_u32 s34, s34, s35
s_mov_b32 s33, 25000
SP_38:
s_load_dwordx16 s[36:51], s[12:13], s34 offset:294912 glc
s_sub_u32 s33, s33, 1
s_cbranch_scc1 SE_39
s_waitcnt lgkmcnt(0)
s_and_b64 s[28:29], s[36:37], s[38:39]
s_or_b64 s[30:31], s[36:37], s[38:39]
s_and_b64 s[28:29], s[28:29], s[40:41]
s_or_b64 s[30:31], s[30:31], s[40:41]
s_and_b64 s[28:29], s[28:29], s[42:43]
s_or_b64 s[30:31], s[30:31], s[42:43]
s_and_b64 s[28:29], s[28:29], s[44:45]
s_or_b64 s[30:31], s[30:31], s[44:45]
s_and_b64 s[28:29], s[28:29], s[46:47]
s_or_b64 s[30:31], s[30:31], s[46:47]
s_and_b64 s[28:29], s[28:29], s[48:49]
s_or_b64 s[30:31], s[30:31], s[48:49]
s_and_b64 s[28:29], s[28:29], s[50:51]
s_or_b64 s[30:31], s[30:31], s[50:51]
s_and_b32 s28, s28, s29
s_or_b32 s30, s30, s31
s_xor_b32 s28, s28, s16
s_xor_b32 s30, s30, s16
s_or_b32 s28, s28, s30
s_and_b32 s28, s28, -1
s_cbranch_scc1 SP_38
SE_39:
s_waitcnt lgkmcnt(0)
S_bq:
s_lshl_b32 s35, s3, 13
s_add_u32 s34, s35, 196608
s_add_u32 s35, s35, 262144
v_and_b32 v30, 15, v1
v_lshlrev_b32 v30, 6, v30
v_lshrrev_b32 v31, 4, v1
v_lshl_add_u32 v30, v31, 4, v30
v_add_u32 v31, 0x1000, v30
buffer_load_dwordx4 v[32:35], v30, s[12:15], s35 offen offset:0 sc1
buffer_load_dwordx4 v[36:39], v30, s[12:15], s35 offen offset:1024 sc1
buffer_load_dwordx4 v[40:43], v30, s[12:15], s35 offen offset:2048 sc1
buffer_load_dwordx4 v[44:47], v30, s[12:15], s35 offen offset:3072 sc1
buffer_load_dwordx4 v[48:51], v31, s[12:15], s35 offen offset:0 sc1
buffer_load_dwordx4 v[52:55], v31, s[12:15], s35 offen offset:1024 sc1
buffer_load_dwordx4 v[56:59], v31, s[12:15], s35 offen offset:2048 sc1
buffer_load_dwordx4 v[60:63], v31, s[12:15], s35 offen offset:3072 sc1
buffer_load_dwordx4 v[64:67], v30, s[12:15], s34 offen offset:0 sc1
buffer_load_dwordx4 v[68:71], v30, s[12:15], s34 offen offset:1024 sc1
buffer_load_dwordx4 v[72:75], v30, s[12:15], s34 offen offset:2048 sc1
buffer_load_dwordx4 v[76:79], v30, s[12:15], s34 offen offset:3072 sc1
buffer_load_dwordx4 v[80:83], v31, s[12:15], s34 offen offset:0 sc1
buffer_load_dwordx4 v[84:87], v31, s[12:15], s34 offen offset:1024 sc1
buffer_load_dwordx4 v[88:91], v31, s[12:15], s34 offen offset:2048 sc1
buffer_load_dwordx4 v[92:95], v31, s[12:15], s34 offen offset:3072 sc1
s_mov_b32 s37, 25000
QB_40:
s_waitcnt vmcnt(15)
v_xor_b32 v32, v120, v32
v_xor_b32 v33, v121, v33
v_xor_b32 v34, v122, v34
v_xor_b32 v35, v123, v35
v_or_b32 v15, v32, v33
v_or3_b32 v15, v34, v35, v15
v_mfma_f32_16x16x32_bf16 v[96:99], v[128:131], v[32:35], 0
v_mfma_f32_16x16x32_bf16 v[100:103], v[160:163], v[32:35], 0
v_mfma_f32_16x16x32_bf16 v[104:107], v[192:195], v[32:35], 0
v_mfma_f32_16x16x32_bf16 v[108:111], v[224:227], v[32:35], 0
s_waitcnt vmcnt(14)
v_xor_b32 v36, v120, v36
v_xor_b32 v37, v121, v37
v_xor_b32 v38, v122, v38
v_xor_b32 v39, v123, v39
v_or3_b32 v15, v36, v37, v15
v_or3_b32 v15, v38, v39, v15
v_mfma_f32_16x16x32_bf16 v[96:99], v[132:135], v[36:39], v[96:99]
v_mfma_f32_16x16x32_bf16 v[100:103], v[164:167], v[36:39], v[100:103]
v_mfma_f32_16x16x32_bf16 v[104:107], v[196:199], v[36:39], v[104:107]
v_mfma_f32_16x16x32_bf16 v[108:111], v[228:231], v[36:39], v[108:111]
s_waitcnt vmcnt(13)
v_xor_b32 v40, v120, v40
v_xor_b32 v41, v121, v41
v_xor_b32 v42, v122, v42
v_xor_b32 v43, v123, v43
v_or3_b32 v15, v40, v41, v15
v_or3_b32 v15, v42, v43, v15
v_mfma_f32_16x16x32_bf16 v[96:99], v[136:139], v[40:43], v[96:99]
v_mfma_f32_16x16x32_bf16 v[100:103], v[168:171], v[40:43], v[100:103]
v_mfma_f32_16x16x32_bf16 v[104:107], v[200:203], v[40:43], v[104:107]
v_mfma_f32_16x16x32_bf16 v[108:111], v[232:235], v[40:43], v[108:111]
s_waitcnt vmcnt(12)
v_xor_b32 v44, v120, v44
v_xor_b32 v45, v121, v45
v_xor_b32 v46, v122, v46
v_xor_b32 v47, v123, v47
v_or3_b32 v15, v44, v45, v15
v_or3_b32 v15, v46, v47, v15
v_mfma_f32_16x16x32_bf16 v[96:99], v[140:143], v[44:47], v[96:99]
v_mfma_f32_16x16x32_bf16 v[100:103], v[172:175], v[44:47], v[100:103]
v_mfma_f32_16x16x32_bf16 v[104:107], v[204:207], v[44:47], v[104:107]
v_mfma_f32_16x16x32_bf16 v[108:111], v[236:239], v[44:47], v[108:111]
s_waitcnt vmcnt(11)
v_xor_b32 v48, v120, v48
v_xor_b32 v49, v121, v49
v_xor_b32 v50, v122, v50
v_xor_b32 v51, v123, v51
v_or3_b32 v15, v48, v49, v15
v_or3_b32 v15, v50, v51, v15
v_mfma_f32_16x16x32_bf16 v[96:99], v[144:147], v[48:51], v[96:99]
v_mfma_f32_16x16x32_bf16 v[100:103], v[176:179], v[48:51], v[100:103]
v_mfma_f32_16x16x32_bf16 v[104:107], v[208:211], v[48:51], v[104:107]
v_mfma_f32_16x16x32_bf16 v[108:111], v[240:243], v[48:51], v[108:111]
s_waitcnt vmcnt(10)
v_xor_b32 v52, v120, v52
v_xor_b32 v53, v121, v53
v_xor_b32 v54, v122, v54
v_xor_b32 v55, v123, v55
v_or3_b32 v15, v52, v53, v15
v_or3_b32 v15, v54, v55, v15
v_mfma_f32_16x16x32_bf16 v[96:99], v[148:151], v[52:55], v[96:99]
v_mfma_f32_16x16x32_bf16 v[100:103], v[180:183], v[52:55], v[100:103]
v_mfma_f32_16x16x32_bf16 v[104:107], v[212:215], v[52:55], v[104:107]
v_mfma_f32_16x16x32_bf16 v[108:111], v[244:247], v[52:55], v[108:111]
s_waitcnt vmcnt(9)
v_xor_b32 v56, v120, v56
v_xor_b32 v57, v121, v57
v_xor_b32 v58, v122, v58
v_xor_b32 v59, v123, v59
v_or3_b32 v15, v56, v57, v15
v_or3_b32 v15, v58, v59, v15
v_mfma_f32_16x16x32_bf16 v[96:99], v[152:155], v[56:59], v[96:99]
v_mfma_f32_16x16x32_bf16 v[100:103], v[184:187], v[56:59], v[100:103]
v_mfma_f32_16x16x32_bf16 v[104:107], v[216:219], v[56:59], v[104:107]
v_mfma_f32_16x16x32_bf16 v[108:111], v[248:251], v[56:59], v[108:111]
s_waitcnt vmcnt(8)
v_xor_b32 v60, v120, v60
v_xor_b32 v61, v121, v61
v_xor_b32 v62, v122, v62
v_xor_b32 v63, v123, v63
v_or3_b32 v15, v60, v61, v15
v_or3_b32 v15, v62, v63, v15
v_mfma_f32_16x16x32_bf16 v[96:99], v[156:159], v[60:63], v[96:99]
v_mfma_f32_16x16x32_bf16 v[100:103], v[188:191], v[60:63], v[100:103]
v_mfma_f32_16x16x32_bf16 v[104:107], v[220:223], v[60:63], v[104:107]
v_mfma_f32_16x16x32_bf16 v[108:111], v[252:255], v[60:63], v[108:111]
s_waitcnt vmcnt(7)
v_xor_b32 v64, v120, v64
v_xor_b32 v65, v121, v65
v_xor_b32 v66, v122, v66
v_xor_b32 v67, v123, v67
v_or3_b32 v15, v64, v65, v15
v_or3_b32 v15, v66, v67, v15
v_mfma_f32_16x16x32_bf16 v[96:99], v[128:131], v[64:67], v[96:99]
v_mfma_f32_16x16x32_bf16 v[100:103], v[160:163], v[64:67], v[100:103]
v_mfma_f32_16x16x32_bf16 v[104:107], v[192:195], v[64:67], v[104:107]
v_mfma_f32_16x16x32_bf16 v[108:111], v[224:227], v[64:67], v[108:111]
s_waitcnt vmcnt(6)
v_xor_b32 v68, v120, v68
v_xor_b32 v69, v121, v69
v_xor_b32 v70, v122, v70
v_xor_b32 v71, v123, v71
v_or3_b32 v15, v68, v69, v15
v_or3_b32 v15, v70, v71, v15
v_mfma_f32_16x16x32_bf16 v[96:99], v[132:135], v[68:71], v[96:99]
v_mfma_f32_16x16x32_bf16 v[100:103], v[164:167], v[68:71], v[100:103]
v_mfma_f32_16x16x32_bf16 v[104:107], v[196:199], v[68:71], v[104:107]
v_mfma_f32_16x16x32_bf16 v[108:111], v[228:231], v[68:71], v[108:111]
s_waitcnt vmcnt(5)
v_xor_b32 v72, v120, v72
v_xor_b32 v73, v121, v73
v_xor_b32 v74, v122, v74
v_xor_b32 v75, v123, v75
v_or3_b32 v15, v72, v73, v15
v_or3_b32 v15, v74, v75, v15
v_mfma_f32_16x16x32_bf16 v[96:99], v[136:139], v[72:75], v[96:99]
v_mfma_f32_16x16x32_bf16 v[100:103], v[168:171], v[72:75], v[100:103]
v_mfma_f32_16x16x32_bf16 v[104:107], v[200:203], v[72:75], v[104:107]
v_mfma_f32_16x16x32_bf16 v[108:111], v[232:235], v[72:75], v[108:111]
s_waitcnt vmcnt(4)
v_xor_b32 v76, v120, v76
v_xor_b32 v77, v121, v77
v_xor_b32 v78, v122, v78
v_xor_b32 v79, v123, v79
v_or3_b32 v15, v76, v77, v15
v_or3_b32 v15, v78, v79, v15
v_mfma_f32_16x16x32_bf16 v[96:99], v[140:143], v[76:79], v[96:99]
v_mfma_f32_16x16x32_bf16 v[100:103], v[172:175], v[76:79], v[100:103]
v_mfma_f32_16x16x32_bf16 v[104:107], v[204:207], v[76:79], v[104:107]
v_mfma_f32_16x16x32_bf16 v[108:111], v[236:239], v[76:79], v[108:111]
s_waitcnt vmcnt(3)
v_xor_b32 v80, v120, v80
v_xor_b32 v81, v121, v81
v_xor_b32 v82, v122, v82
v_xor_b32 v83, v123, v83
v_or3_b32 v15, v80, v81, v15
v_or3_b32 v15, v82, v83, v15
v_mfma_f32_16x16x32_bf16 v[96:99], v[144:147], v[80:83], v[96:99]
v_mfma_f32_16x16x32_bf16 v[100:103], v[176:179], v[80:83], v[100:103]
v_mfma_f32_16x16x32_bf16 v[104:107], v[208:211], v[80:83], v[104:107]
v_mfma_f32_16x16x32_bf16 v[108:111], v[240:243], v[80:83], v[108:111]
s_waitcnt vmcnt(2)
v_xor_b32 v84, v120, v84
v_xor_b32 v85, v121, v85
v_xor_b32 v86, v122, v86
v_xor_b32 v87, v123, v87
v_or3_b32 v15, v84, v85, v15
v_or3_b32 v15, v86, v87, v15
v_mfma_f32_16x16x32_bf16 v[96:99], v[148:151], v[84:87], v[96:99]
v_mfma_f32_16x16x32_bf16 v[100:103], v[180:183], v[84:87], v[100:103]
v_mfma_f32_16x16x32_bf16 v[104:107], v[212:215], v[84:87], v[104:107]
v_mfma_f32_16x16x32_bf16 v[108:111], v[244:247], v[84:87], v[108:111]
s_waitcnt vmcnt(1)
v_xor_b32 v88, v120, v88
v_xor_b32 v89, v121, v89
v_xor_b32 v90, v122, v90
v_xor_b32 v91, v123, v91
v_or3_b32 v15, v88, v89, v15
v_or3_b32 v15, v90, v91, v15
v_mfma_f32_16x16x32_bf16 v[96:99], v[152:155], v[88:91], v[96:99]
v_mfma_f32_16x16x32_bf16 v[100:103], v[184:187], v[88:91], v[100:103]
v_mfma_f32_16x16x32_bf16 v[104:107], v[216:219], v[88:91], v[104:107]
v_mfma_f32_16x16x32_bf16 v[108:111], v[248:251], v[88:91], v[108:111]
s_waitcnt vmcnt(0)
v_xor_b32 v92, v120, v92
v_xor_b32 v93, v121, v93
v_xor_b32 v94, v122, v94
v_xor_b32 v95, v123, v95
v_or3_b32 v15, v92, v93, v15
v_or3_b32 v15, v94, v95, v15
v_mfma_f32_16x16x32_bf16 v[96:99], v[156:159], v[92:95], v[96:99]
v_mfma_f32_16x16x32_bf16 v[100:103], v[188:191], v[92:95], v[100:103]
v_mfma_f32_16x16x32_bf16 v[104:107], v[220:223], v[92:95], v[104:107]
v_mfma_f32_16x16x32_bf16 v[108:111], v[252:255], v[92:95], v[108:111]
v_and_b32 v14, 0x00010001, v15
v_cmp_ne_u32 vcc, 0, v14
s_nop 4
s_cbranch_vccz QBE_41
s_sub_u32 s37, s37, 1
s_cbranch_scc1 QBE_41
v_and_b32 v30, 15, v1
v_lshlrev_b32 v30, 6, v30
v_lshrrev_b32 v31, 4, v1
v_lshl_add_u32 v30, v31, 4, v30
v_add_u32 v31, 0x1000, v30
buffer_load_dwordx4 v[32:35], v30, s[12:15], s35 offen offset:0 sc1
buffer_load_dwordx4 v[36:39], v30, s[12:15], s35 offen offset:1024 sc1
buffer_load_dwordx4 v[40:43], v30, s[12:15], s35 offen offset:2048 sc1
buffer_load_dwordx4 v[44:47], v30, s[12:15], s35 offen offset:3072 sc1
buffer_load_dwordx4 v[48:51], v31, s[12:15], s35 offen offset:0 sc1
buffer_load_dwordx4 v[52:55], v31, s[12:15], s35 offen offset:1024 sc1
buffer_load_dwordx4 v[56:59], v31, s[12:15], s35 offen offset:2048 sc1
buffer_load_dwordx4 v[60:63], v31, s[12:15], s35 offen offset:3072 sc1
buffer_load_dwordx4 v[64:67], v30, s[12:15], s34 offen offset:0 sc1
buffer_load_dwordx4 v[68:71], v30, s[12:15], s34 offen offset:1024 sc1
buffer_load_dwordx4 v[72:75], v30, s[12:15], s34 offen offset:2048 sc1
buffer_load_dwordx4 v[76:79], v30, s[12:15], s34 offen offset:3072 sc1
buffer_load_dwordx4 v[80:83], v31, s[12:15], s34 offen offset:0 sc1
buffer_load_dwordx4 v[84:87], v31, s[12:15], s34 offen offset:1024 sc1
buffer_load_dwordx4 v[88:91], v31, s[12:15], s34 offen offset:2048 sc1
buffer_load_dwordx4 v[92:95], v31, s[12:15], s34 offen offset:3072 sc1
s_branch QB_40
QBE_41:
s_lshl_b32 s34, s3, 10
v_add_u32 v30, s34, v24
ds_write_b128 v30, v[96:99] offset:12288
ds_write_b128 v30, v[100:103] offset:16384
ds_write_b128 v30, v[104:107] offset:20480
ds_write_b128 v30, v[108:111] offset:24576
s_mov_b32 s33, 200000
LW_42:
ds_read_b32 v13, v2 offset:16
s_sub_u32 s33, s33, 1
s_cbranch_scc1 LE_43
s_waitcnt lgkmcnt(0)
v_readfirstlane_b32 s32, v13
s_nop 0
s_cmp_ge_u32 s32, 4
s_cbranch_scc0 LW_42
LE_43:
s_waitcnt lgkmcnt(0)
ds_read_b128 v[128:131], v112 offset:0
ds_read_b128 v[132:135], v113 offset:0
ds_read_b128 v[136:139], v114 offset:0
ds_read_b128 v[140:143], v115 offset:0
ds_read_b128 v[144:147], v112 offset:256
ds_read_b128 v[148:151], v113 offset:256
ds_read_b128 v[152:155], v114 offset:256
ds_read_b128 v[156:159], v115 offset:256
ds_read_b128 v[160:163], v112 offset:32768
ds_read_b128 v[164:167], v113 offset:32768
ds_read_b128 v[168:171], v114 offset:32768
ds_read_b128 v[172:175], v115 offset:32768
ds_read_b128 v[176:179], v112 offset:33024
ds_read_b128 v[180:183], v113 offset:33024
ds_read_b128 v[184:187], v114 offset:33024
ds_read_b128 v[188:191], v115 offset:33024
s_waitcnt lgkmcnt(15)
v_mfma_f32_16x16x32_bf16 v[96:99], v[128:131], v[32:35], 0
v_mfma_f32_16x16x32_bf16 v[96:99], v[128:131], v[64:67], v[96:99]
s_waitcnt lgkmcnt(14)
v_mfma_f32_16x16x32_bf16 v[96:99], v[132:135], v[36:39], v[96:99]
v_mfma_f32_16x16x32_bf16 v[96:99], v[132:135], v[68:71], v[96:99]
s_waitcnt lgkmcnt(13)
v_mfma_f32_16x16x32_bf16 v[96:99], v[136:139], v[40:43], v[96:99]
v_mfma_f32_16x16x32_bf16 v[96:99], v[136:139], v[72:75], v[96:99]
s_waitcnt lgkmcnt(12)
v_mfma_f32_16x16x32_bf16 v[96:99], v[140:143], v[44:47], v[96:99]
v_mfma_f32_16x16x32_bf16 v[96:99], v[140:143], v[76:79], v[96:99]
s_waitcnt lgkmcnt(11)
v_mfma_f32_16x16x32_bf16 v[96:99], v[144:147], v[48:51], v[96:99]
v_mfma_f32_16x16x32_bf16 v[96:99], v[144:147], v[80:83], v[96:99]
s_waitcnt lgkmcnt(10)
v_mfma_f32_16x16x32_bf16 v[96:99], v[148:151], v[52:55], v[96:99]
v_mfma_f32_16x16x32_bf16 v[96:99], v[148:151], v[84:87], v[96:99]
s_waitcnt lgkmcnt(9)
v_mfma_f32_16x16x32_bf16 v[96:99], v[152:155], v[56:59], v[96:99]
v_mfma_f32_16x16x32_bf16 v[96:99], v[152:155], v[88:91], v[96:99]
s_waitcnt lgkmcnt(8)
v_mfma_f32_16x16x32_bf16 v[96:99], v[156:159], v[60:63], v[96:99]
v_mfma_f32_16x16x32_bf16 v[96:99], v[156:159], v[92:95], v[96:99]
s_waitcnt lgkmcnt(7)
v_mfma_f32_16x16x32_bf16 v[100:103], v[160:163], v[32:35], 0
v_mfma_f32_16x16x32_bf16 v[100:103], v[160:163], v[64:67], v[100:103]
s_waitcnt lgkmcnt(6)
v_mfma_f32_16x16x32_bf16 v[100:103], v[164:167], v[36:39], v[100:103]
v_mfma_f32_16x16x32_bf16 v[100:103], v[164:167], v[68:71], v[100:103]
s_waitcnt lgkmcnt(5)
v_mfma_f32_16x16x32_bf16 v[100:103], v[168:171], v[40:43], v[100:103]
v_mfma_f32_16x16x32_bf16 v[100:103], v[168:171], v[72:75], v[100:103]
s_waitcnt lgkmcnt(4)
v_mfma_f32_16x16x32_bf16 v[100:103], v[172:175], v[44:47], v[100:103]
v_mfma_f32_16x16x32_bf16 v[100:103], v[172:175], v[76:79], v[100:103]
s_waitcnt lgkmcnt(3)
v_mfma_f32_16x16x32_bf16 v[100:103], v[176:179], v[48:51], v[100:103]
v_mfma_f32_16x16x32_bf16 v[100:103], v[176:179], v[80:83], v[100:103]
s_waitcnt lgkmcnt(2)
v_mfma_f32_16x16x32_bf16 v[100:103], v[180:183], v[52:55], v[100:103]
v_mfma_f32_16x16x32_bf16 v[100:103], v[180:183], v[84:87], v[100:103]
s_waitcnt lgkmcnt(1)
v_mfma_f32_16x16x32_bf16 v[100:103], v[184:187], v[56:59], v[100:103]
v_mfma_f32_16x16x32_bf16 v[100:103], v[184:187], v[88:91], v[100:103]
s_waitcnt lgkmcnt(0)
v_mfma_f32_16x16x32_bf16 v[100:103], v[188:191], v[60:63], v[100:103]
v_mfma_f32_16x16x32_bf16 v[100:103], v[188:191], v[92:95], v[100:103]
s_mov_b32 s33, 200000
LW_44:
ds_read_b32 v13, v2 offset:20
s_sub_u32 s33, s33, 1
s_cbranch_scc1 LE_45
s_waitcnt lgkmcnt(0)
v_readfirstlane_b32 s32, v13
s_nop 0
s_cmp_ge_u32 s32, 4
s_cbranch_scc0 LW_44
LE_45:
s_waitcnt lgkmcnt(0)
ds_read_b128 v[192:195], v116 offset:0
ds_read_b128 v[196:199], v117 offset:0
ds_read_b128 v[200:203], v118 offset:0
ds_read_b128 v[204:207], v119 offset:0
ds_read_b128 v[208:211], v116 offset:256
ds_read_b128 v[212:215], v117 offset:256
ds_read_b128 v[216:219], v118 offset:256
ds_read_b128 v[220:223], v119 offset:256
ds_read_b128 v[224:227], v116 offset:32768
ds_read_b128 v[228:231], v117 offset:32768
ds_read_b128 v[232:235], v118 offset:32768
ds_read_b128 v[236:239], v119 offset:32768
ds_read_b128 v[240:243], v116 offset:33024
ds_read_b128 v[244:247], v117 offset:33024
ds_read_b128 v[248:251], v118 offset:33024
ds_read_b128 v[252:255], v119 offset:33024
s_waitcnt lgkmcnt(15)
v_mfma_f32_16x16x32_bf16 v[104:107], v[192:195], v[32:35], 0
v_mfma_f32_16x16x32_bf16 v[104:107], v[192:195], v[64:67], v[104:107]
s_waitcnt lgkmcnt(14)
v_mfma_f32_16x16x32_bf16 v[104:107], v[196:199], v[36:39], v[104:107]
v_mfma_f32_16x16x32_bf16 v[104:107], v[196:199], v[68:71], v[104:107]
s_waitcnt lgkmcnt(13)
v_mfma_f32_16x16x32_bf16 v[104:107], v[200:203], v[40:43], v[104:107]
v_mfma_f32_16x16x32_bf16 v[104:107], v[200:203], v[72:75], v[104:107]
s_waitcnt lgkmcnt(12)
v_mfma_f32_16x16x32_bf16 v[104:107], v[204:207], v[44:47], v[104:107]
v_mfma_f32_16x16x32_bf16 v[104:107], v[204:207], v[76:79], v[104:107]
s_waitcnt lgkmcnt(11)
v_mfma_f32_16x16x32_bf16 v[104:107], v[208:211], v[48:51], v[104:107]
v_mfma_f32_16x16x32_bf16 v[104:107], v[208:211], v[80:83], v[104:107]
s_waitcnt lgkmcnt(10)
v_mfma_f32_16x16x32_bf16 v[104:107], v[212:215], v[52:55], v[104:107]
v_mfma_f32_16x16x32_bf16 v[104:107], v[212:215], v[84:87], v[104:107]
s_waitcnt lgkmcnt(9)
v_mfma_f32_16x16x32_bf16 v[104:107], v[216:219], v[56:59], v[104:107]
v_mfma_f32_16x16x32_bf16 v[104:107], v[216:219], v[88:91], v[104:107]
s_waitcnt lgkmcnt(8)
v_mfma_f32_16x16x32_bf16 v[104:107], v[220:223], v[60:63], v[104:107]
v_mfma_f32_16x16x32_bf16 v[104:107], v[220:223], v[92:95], v[104:107]
s_waitcnt lgkmcnt(7)
v_mfma_f32_16x16x32_bf16 v[108:111], v[224:227], v[32:35], 0
v_mfma_f32_16x16x32_bf16 v[108:111], v[224:227], v[64:67], v[108:111]
s_waitcnt lgkmcnt(6)
v_mfma_f32_16x16x32_bf16 v[108:111], v[228:231], v[36:39], v[108:111]
v_mfma_f32_16x16x32_bf16 v[108:111], v[228:231], v[68:71], v[108:111]
s_waitcnt lgkmcnt(5)
v_mfma_f32_16x16x32_bf16 v[108:111], v[232:235], v[40:43], v[108:111]
v_mfma_f32_16x16x32_bf16 v[108:111], v[232:235], v[72:75], v[108:111]
s_waitcnt lgkmcnt(4)
v_mfma_f32_16x16x32_bf16 v[108:111], v[236:239], v[44:47], v[108:111]
v_mfma_f32_16x16x32_bf16 v[108:111], v[236:239], v[76:79], v[108:111]
s_waitcnt lgkmcnt(3)
v_mfma_f32_16x16x32_bf16 v[108:111], v[240:243], v[48:51], v[108:111]
v_mfma_f32_16x16x32_bf16 v[108:111], v[240:243], v[80:83], v[108:111]
s_waitcnt lgkmcnt(2)
v_mfma_f32_16x16x32_bf16 v[108:111], v[244:247], v[52:55], v[108:111]
v_mfma_f32_16x16x32_bf16 v[108:111], v[244:247], v[84:87], v[108:111]
s_waitcnt lgkmcnt(1)
v_mfma_f32_16x16x32_bf16 v[108:111], v[248:251], v[56:59], v[108:111]
v_mfma_f32_16x16x32_bf16 v[108:111], v[248:251], v[88:91], v[108:111]
s_waitcnt lgkmcnt(0)
v_mfma_f32_16x16x32_bf16 v[108:111], v[252:255], v[60:63], v[108:111]
v_mfma_f32_16x16x32_bf16 v[108:111], v[252:255], v[92:95], v[108:111]
s_mov_b32 s35, 0x3db8aa3b
s_nop 7
s_cmp_eq_u32 s3, 0
s_cbranch_scc1 XV_47
s_cmp_eq_u32 s3, 1
s_cbranch_scc1 XV_48
s_cmp_eq_u32 s3, 2
s_cbranch_scc1 XV_49
XV_50:
ds_write_b128 v24, v[96:99] offset:2048
ds_write_b128 v24, v[100:103] offset:4096
ds_write_b128 v24, v[104:107] offset:6144
v_mov_b32 v20, v108
v_mov_b32 v21, v109
v_mov_b32 v22, v110
v_mov_b32 v23, v111
s_branch XJ_46
XV_47:
ds_write_b128 v24, v[100:103] offset:5120
ds_write_b128 v24, v[104:107] offset:7168
ds_write_b128 v24, v[108:111] offset:9216
v_mov_b32 v20, v96
v_mov_b32 v21, v97
v_mov_b32 v22, v98
v_mov_b32 v23, v99
s_branch XJ_46
XV_48:
ds_write_b128 v24, v[96:99] offset:0
ds_write_b128 v24, v[104:107] offset:8192
ds_write_b128 v24, v[108:111] offset:10240
v_mov_b32 v20, v100
v_mov_b32 v21, v101
v_mov_b32 v22, v102
v_mov_b32 v23, v103
s_branch XJ_46
XV_49:
ds_write_b128 v24, v[96:99] offset:1024
ds_write_b128 v24, v[100:103] offset:3072
ds_write_b128 v24, v[108:111] offset:11264
v_mov_b32 v20, v104
v_mov_b32 v21, v105
v_mov_b32 v22, v106
v_mov_b32 v23, v107
XJ_46:
s_waitcnt lgkmcnt(0)
s_barrier
ds_read_b128 v[96:99], v25 offset:0
ds_read_b128 v[100:103], v25 offset:1024
ds_read_b128 v[104:107], v25 offset:2048
s_waitcnt lgkmcnt(0)
v_add_f32 v20, v20, v96
v_add_f32 v100, v100, v104
v_add_f32 v21, v21, v97
v_add_f32 v101, v101, v105
v_add_f32 v22, v22, v98
v_add_f32 v102, v102, v106
v_add_f32 v23, v23, v99
v_add_f32 v103, v103, v107
v_add_f32 v20, v20, v100
v_add_f32 v21, v21, v101
v_add_f32 v22, v22, v102
v_add_f32 v23, v23, v103
v_max3_f32 v26, v20, v21, v22
v_max_f32 v26, v26, v23
v_mov_b32 v30, v26
s_nop 1
v_permlane16_swap_b32 v26, v30
v_max_f32 v26, v26, v30
v_mov_b32 v30, v26
s_nop 1
v_permlane32_swap_b32 v26, v30
v_max_f32 v26, v26, v30
s_mov_b64 exec, 0xffff
ds_write_b32 v28, v26 offset:16
s_mov_b64 exec, -1
s_waitcnt lgkmcnt(0)
s_barrier
ds_read_b128 v[96:99], v27
ds_read_b128 v[100:103], v27 offset:16
s_waitcnt lgkmcnt(0)
v_max3_f32 v26, v96, v97, v98
v_max3_f32 v30, v99, v100, v101
v_max3_f32 v26, v26, v102, v103
v_max_f32 v26, v26, v30
v_mul_f32 v26, s35, v26
v_and_b32 v26, v19, v26
v_fma_f32 v20, v20, s35, -v26
v_fma_f32 v21, v21, s35, -v26
v_fma_f32 v22, v22, s35, -v26
v_fma_f32 v23, v23, s35, -v26
v_exp_f32 v20, v20
v_exp_f32 v21, v21
v_exp_f32 v22, v22
v_exp_f32 v23, v23
v_cvt_pk_bf16_f32 v96, v20, v21
v_cvt_pk_bf16_f32 v97, v22, v23
ds_write_b64 v29, v[96:97]
v_add_f32 v20, v20, v21
v_add_f32 v22, v22, v23
v_add_f32 v20, v20, v22
v_mov_b32 v30, v20
s_nop 1
v_permlane16_swap_b32 v20, v30
v_add_f32 v20, v20, v30
v_mov_b32 v30, v20
s_nop 1
v_permlane32_swap_b32 v20, v30
v_add_f32 v20, v20, v30
s_mov_b64 exec, 0xffff
ds_write_b32 v28, v20 offset:528
s_mov_b64 exec, -1
s_waitcnt lgkmcnt(0)
s_barrier
s_setprio 0
v_lshrrev_b32 v95, 5, v1
v_lshlrev_b32 v94, 2, v95
v_and_b32 v92, 31, v1
v_xor_b32 v92, v92, v94
v_lshlrev_b32 v92, 4, v92
v_lshl_add_u32 v92, v95, 9, v92
v_xor_b32 v224, 0, v92
v_xor_b32 v225, 1152, v92
v_xor_b32 v226, 2064, v92
v_xor_b32 v227, 3216, v92
v_xor_b32 v228, 4128, v92
v_xor_b32 v229, 5280, v92
v_xor_b32 v230, 6192, v92
v_xor_b32 v231, 7344, v92
s_lshl_b32 s47, s3, 14
s_add_u32 s47, s47, 16384
v_and_b32 v94, 3, v1
v_lshlrev_b32 v94, 2, v94
v_bfe_u32 v95, v1, 2, 2
v_add_u32 v94, v94, v95
v_lshlrev_b32 v92, 9, v94
v_lshrrev_b32 v95, 4, v1
v_and_b32 v94, 15, v1
v_xor_b32 v93, v95, v94
v_lshl_add_u32 v92, v93, 4, v92
v_add_u32 v92, s47, v92
v_xor_b32 v232, 0, v92
v_xor_b32 v233, 64, v92
v_xor_b32 v234, 128, v92
v_xor_b32 v235, 192, v92
v_lshlrev_b32 v93, 9, v95
v_lshl_add_u32 v93, v94, 4, v93
v_add_u32 v94, 0x1000, v93
v_readfirstlane_b32 s31, v0
s_nop 0
s_and_b32 s45, s31, 7
s_lshr_b32 s48, s31, 3
s_lshr_b32 s28, s31, 6
s_add_u32 s48, s48, s28
s_add_u32 s48, s48, s3
s_and_b32 s48, s48, 3
s_lshl_b32 s49, s45, 2
s_add_u32 s49, s49, s48
s_lshl_b32 s49, s49, 7
s_mul_i32 s58, s45, 0
s_mul_i32 s28, s48, 0
s_add_u32 s58, s58, s28
s_lshl_b32 s45, s45, 22
s_mov_b32 s46, 0x3db8aa3b
s_add_u32 s4, s20, s45
s_addc_u32 s5, s21, 0
s_mov_b32 s6, 4194304
s_mov_b32 s7, 0x00020000
s_add_u32 s8, s22, s45
s_addc_u32 s9, s23, 0
s_mov_b32 s10, 4194304
s_mov_b32 s11, 0x00020000
s_load_dwordx4 s[68:71], s[0:1], 72
s_lshl_b32 s48, s48, 13
s_mov_b32 s52, 16
v_mov_b32 v26, 0xf149f2ca
v_mov_b32 v27, 0
v_mov_b32 v64, 0
v_mov_b32 v65, 0
v_mov_b32 v66, 0
v_mov_b32 v67, 0
v_mov_b32 v68, 0
v_mov_b32 v69, 0
v_mov_b32 v70, 0
v_mov_b32 v71, 0
v_bfe_u32 v103, v1, 3, 1
v_lshlrev_b32 v103, 14, v103
v_lshrrev_b32 v23, 5, v1
v_lshl_add_u32 v103, v23, 12, v103
v_bfe_u32 v23, v1, 4, 1
v_lshl_add_u32 v103, v23, 6, v103
v_and_b32 v23, 7, v1
v_lshl_add_u32 v103, v23, 3, v103
v_add_u32 v104, 0x2000, v103
s_lshr_b32 s34, s31, 3
s_and_b32 s35, s31, 7
s_and_b32 s56, s2, 7
s_lshl_b32 s56, s56, 3
s_lshr_b32 s28, s2, 5
s_add_u32 s56, s56, s28
s_lshl_b32 s38, s35, 15
s_lshl_b32 s28, s34, 7
s_add_u32 s38, s38, s28
s_add_u32 s38, s38, 458752
s_lshl_b32 s39, s35, 9
s_lshl_b32 s28, s34, 3
s_add_u32 s39, s39, s28
s_add_u32 s39, s39, 983040
v_lshrrev_b32 v105, 4, v1
v_lshlrev_b32 v105, 12, v105
v_bfe_u32 v23, v1, 3, 1
v_lshl_add_u32 v105, v23, 8, v105
v_and_b32 v23, 3, v1
v_lshl_add_u32 v105, v23, 14, v105
v_and_b32 v23, 7, v1
v_lshlrev_b32 v23, 2, v23
v_lshrrev_b32 v23, v23, s16
v_bfe_u32 v24, v23, 1, 1
v_bfe_u32 v242, v23, 0, 1
v_lshl_or_b32 v242, v24, 16, v242
v_bfe_u32 v24, v23, 3, 1
v_bfe_u32 v243, v23, 2, 1
v_lshl_or_b32 v243, v24, 16, v243
v_add_u32 v101, 147456, v18
v_and_b32 v102, 15, v1
v_lshlrev_b32 v102, 3, v102
v_add_u32 v102, 161792, v102
s_lshl_b32 s28, s3, 11
v_add_u32 v240, s28, v101
s_lshl_b32 s28, s3, 7
v_add_u32 v241, s28, v102
v_bfe_u32 v96, s16, 0, 8
v_bfe_u32 v97, s16, 8, 8
v_bfe_u32 v98, s16, 16, 8
v_bfe_u32 v99, s16, 24, 8
s_and_b32 s60, s56, 0
s_lshl_b32 s60, s60, 2
s_add_u32 s60, s60, s101
s_lshl_b32 s60, s60, 12
s_lshr_b32 s28, s56, 2
s_lshl_b32 s28, s28, 8
s_add_u32 s60, s60, s28
s_lshl_b32 s40, s56, 12
s_add_u32 s40, s40, 458752
v_lshrrev_b32 v106, 4, v1
v_bfe_u32 v23, v1, 2, 2
v_and_b32 v24, 3, v1
v_lshl_add_u32 v107, v106, 3, v23
v_lshlrev_b32 v107, 7, v107
v_lshl_add_u32 v107, v24, 3, v107
v_add_u32 v107, 81920, v107
v_lshl_add_u32 v108, v23, 3, v106
v_lshlrev_b32 v108, 8, v108
v_lshl_add_u32 v108, v24, 3, v108
v_lshl_add_u32 v108, v23, 6, v108
v_and_b32 v24, 1, v106
v_lshl_add_u32 v108, v24, 5, v108
v_lshrrev_b32 v110, 4, v1
v_mul_u32_u24 v109, 7168, v110
v_and_b32 v111, 1, v110
v_lshrrev_b32 v110, 1, v110
v_lshl_add_u32 v110, v110, 3, v111
v_mul_u32_u24 v110, 3584, v110
v_and_b32 v23, 15, v1
v_lshl_add_u32 v109, v23, 4, v109
v_lshl_add_u32 v110, v23, 4, v110
v_mov_b32 v24, 0x7ff00000
s_cmp_eq_u32 s101, 3
s_cselect_b32 s28, 8, 16
v_lshrrev_b32 v109, 4, v1
v_and_b32 v25, 1, v109
v_lshlrev_b32 v25, 1, v25
v_xor_b32 v25, v25, v23
v_mul_u32_u24 v109, 896, v109
v_xor_b32 v28, 0, v25
v_lshl_add_u32 v236, v28, 4, v109
v_cmp_le_u32 vcc, s28, v28
s_nop 1
v_cndmask_b32 v236, v236, v24, vcc
v_xor_b32 v28, 4, v25
v_lshl_add_u32 v237, v28, 4, v109
v_cmp_le_u32 vcc, s28, v28
s_nop 1
v_cndmask_b32 v237, v237, v24, vcc
v_xor_b32 v28, 8, v25
v_lshl_add_u32 v238, v28, 4, v109
v_cmp_le_u32 vcc, s28, v28
s_nop 1
v_cndmask_b32 v238, v238, v24, vcc
v_xor_b32 v28, 12, v25
v_lshl_add_u32 v239, v28, 4, v109
v_cmp_le_u32 vcc, s28, v28
s_nop 1
v_cndmask_b32 v239, v239, v24, vcc
s_and_b32 s29, s2, 3
s_cmp_eq_u32 s29, 3
s_cselect_b32 s28, 8, 16
v_cmp_le_u32 vcc, s28, v23
s_nop 1
v_cndmask_b32 v110, v110, v24, vcc
s_mul_i32 s42, s56, 57344
s_lshl_b32 s28, s101, 8
s_add_u32 s42, s42, s28
s_lshr_b32 s43, s2, 2
s_mul_i32 s43, s43, 57344
s_lshl_b32 s28, s29, 8
s_add_u32 s43, s43, s28
v_bfe_u32 v23, v1, 3, 1
v_lshlrev_b32 v23, 9, v23
v_lshrrev_b32 v24, 4, v1
v_lshl_add_u32 v23, v24, 4, v23
v_add_u32 v23, 160768, v23
s_mov_b32 s33, 200000
LW_51:
ds_read_b32 v13, v2 offset:4
s_sub_u32 s33, s33, 1
s_cbranch_scc1 LE_52
s_waitcnt lgkmcnt(0)
v_readfirstlane_b32 s32, v13
s_nop 0
s_cmp_ge_u32 s32, 4
s_cbranch_scc1 LE_52
s_sleep 1
s_branch LW_51
LE_52:
s_waitcnt lgkmcnt(0)
ds_read_b128 v[32:35], v23 offset:0
ds_read_b128 v[36:39], v23 offset:64
ds_read_b128 v[40:43], v23 offset:128
ds_read_b128 v[44:47], v23 offset:192
ds_read_b128 v[48:51], v23 offset:256
ds_read_b128 v[52:55], v23 offset:320
ds_read_b128 v[56:59], v23 offset:384
ds_read_b128 v[60:63], v23 offset:448
s_waitcnt lgkmcnt(0)
s_mov_b32 s33, 200000
LW_53:
ds_read_b32 v13, v2 offset:64
s_sub_u32 s33, s33, 1
s_cbranch_scc1 LE_54
s_waitcnt lgkmcnt(0)
v_readfirstlane_b32 s32, v13
s_nop 0
s_cmp_ge_u32 s32, 4
s_cbranch_scc1 LE_54
s_sleep 2
s_branch LW_53
LE_54:
s_waitcnt lgkmcnt(0)
s_mov_b64 s[50:51], 1
s_atomic_add_x2 s[50:51], s[12:13], s49 offset:319488 glc
s_branch S_next
S_A:
v_mov_b32 v12, 0
v_mov_b32 v2, 163072
v_mov_b32 v3, 1
s_bfe_u32 s101, s2, 0x20003
s_and_b32 s28, s2, 7
s_and_b32 s31, s2, 0xc0
s_lshl_b32 s28, s28, 3
s_add_u32 s31, s31, s28
s_bfe_u32 s28, s2, 0x30003
s_add_u32 s31, s31, s28
v_mov_b32 v0, s31
v_mov_b32 v13, 0
v_lshl_add_u32 v14, v1, 2, v2
s_mov_b32 exec_hi, 0
ds_write_b32 v14, v13
s_mov_b64 exec, -1
v_lshlrev_b32 v18, 4, v1
s_waitcnt lgkmcnt(0)
s_mov_b32 s12, s62
s_mov_b32 s13, s63
s_mov_b32 s14, 3407872
s_mov_b32 s15, 0x00020000
s_load_dword s16, s[12:13], 0
s_mov_b64 s[26:27], s[58:59]
s_mov_b64 s[20:21], s[38:39]
s_mov_b64 s[22:23], s[40:41]
s_mov_b64 s[24:25], s[44:45]
s_setprio 3
v_and_b32 v13, 1, v1
v_cmp_eq_u32 vcc, 1, v13
v_mov_b32 v14, 0x0c0c0100
v_mov_b32 v15, 0x01000c0c
v_cndmask_b32 v14, v14, v15, vcc
v_mov_b32 v31, 0x0c0c0302
v_mov_b32 v15, 0x03020c0c
v_cndmask_b32 v15, v31, v15, vcc
v_bfe_u32 v13, v1, 1, 2
v_mov_b32 v31, 0x0c0c0c0c
v_cmp_eq_u32 vcc, 0, v13
s_nop 1
v_cndmask_b32 v4, v31, v14, vcc
v_cndmask_b32 v8, v31, v15, vcc
v_cmp_eq_u32 vcc, 1, v13
s_nop 1
v_cndmask_b32 v5, v31, v14, vcc
v_cndmask_b32 v9, v31, v15, vcc
v_cmp_eq_u32 vcc, 2, v13
s_nop 1
v_cndmask_b32 v6, v31, v14, vcc
v_cndmask_b32 v10, v31, v15, vcc
v_cmp_eq_u32 vcc, 3, v13
s_nop 1
v_cndmask_b32 v7, v31, v14, vcc
v_cndmask_b32 v11, v31, v15, vcc
v_mov_b32 v16, 0x07060302
v_mov_b32 v17, 0xfffefffe
v_mov_b32 v19, 0xffffff00
s_waitcnt vmcnt(3)
v_xor_b32 v21, 128, v20
s_add_u32 m0, s35, 4096
s_nop 0
buffer_load_dwordx4 v21, s[4:7], s34 offen nt lds
s_add_u32 s34, s34, 16384
s_waitcnt vmcnt(3)
v_xor_b32 v21, 160, v20
s_add_u32 m0, s35, 5120
s_nop 0
buffer_load_dwordx4 v21, s[4:7], s34 offen nt lds
s_add_u32 s34, s34, 16384
s_waitcnt vmcnt(3)
v_xor_b32 v21, 192, v20
s_add_u32 m0, s35, 6144
s_nop 0
buffer_load_dwordx4 v21, s[4:7], s34 offen nt lds
s_add_u32 s34, s34, 16384
s_waitcnt vmcnt(3)
v_xor_b32 v21, 224, v20
s_add_u32 m0, s35, 7168
s_nop 0
buffer_load_dwordx4 v21, s[4:7], s34 offen nt lds
s_add_u32 s34, s34, 16384
s_waitcnt vmcnt(3)
v_xor_b32 v21, 0, v20
s_add_u32 m0, s35, 8192
s_nop 0
buffer_load_dwordx4 v21, s[4:7], s34 offen nt lds
s_add_u32 s34, s34, 16384
s_waitcnt vmcnt(3)
v_xor_b32 v21, 32, v20
s_add_u32 m0, s35, 9216
s_nop 0
buffer_load_dwordx4 v21, s[4:7], s34 offen nt lds
s_add_u32 s34, s34, 16384
s_waitcnt vmcnt(3)
v_xor_b32 v21, 64, v20
s_add_u32 m0, s35, 10240
s_nop 0
buffer_load_dwordx4 v21, s[4:7], s34 offen nt lds
s_add_u32 s34, s34, 16384
s_waitcnt vmcnt(3)
v_xor_b32 v21, 96, v20
s_add_u32 m0, s35, 11264
s_nop 0
buffer_load_dwordx4 v21, s[4:7], s34 offen nt lds
s_add_u32 s34, s34, 16384
s_waitcnt vmcnt(3)
v_xor_b32 v21, 128, v20
s_add_u32 m0, s35, 12288
s_nop 0
buffer_load_dwordx4 v21, s[4:7], s34 offen nt lds
s_add_u32 s34, s34, 16384
s_waitcnt vmcnt(3)
v_xor_b32 v21, 160, v20
s_add_u32 m0, s35, 13312
s_nop 0
buffer_load_dwordx4 v21, s[4:7], s34 offen nt lds
s_add_u32 s34, s34, 16384
s_waitcnt vmcnt(3)
v_xor_b32 v21, 192, v20
s_add_u32 m0, s35, 14336
s_nop 0
buffer_load_dwordx4 v21, s[4:7], s34 offen nt lds
s_add_u32 s34, s34, 16384
s_waitcnt vmcnt(3)
v_xor_b32 v21, 224, v20
s_add_u32 m0, s35, 15360
s_nop 0
buffer_load_dwordx4 v21, s[4:7], s34 offen nt lds
s_waitcnt lgkmcnt(0)
s_add_u32 s16, s16, 0x01010101
s_and_b32 s17, s16, 0xff
s_bfe_u32 s18, s16, 0x80010
s_lshl_b32 s28, s3, 10
s_add_u32 s28, s28, 139264
v_add_u32 v24, s28, v1
v_and_b32 v20, 15, v1
v_lshrrev_b32 v21, 4, v1
v_xor_b32 v21, v21, v20
s_and_b32 s28, s3, 1
s_lshl_b32 s28, s28, 3
v_xor_b32 v21, s28, v21
v_lshlrev_b32 v21, 4, v21
v_lshl_add_u32 v21, v20, 9, v21
s_lshr_b32 s28, s3, 1
s_lshl_b32 s28, s28, 8
v_add_u32 v25, s28, v21
v_xor_b32 v26, 64, v25
s_bfe_u32 s34, s2, 0x40002
s_lshl_b32 s34, s34, 2
s_add_u32 s34, s34, s3
s_lshl_b32 s34, s34, 8
s_lshr_b32 s35, s16, 16
s_mov_b32 s33, 25000
SP_55:
s_load_dwordx16 s[36:51], s[12:13], s34 offset:131072 glc
s_load_dwordx16 s[52:67], s[12:13], s34 offset:131136 glc
s_load_dwordx16 s[68:83], s[12:13], s34 offset:131200 glc
s_load_dwordx16 s[84:99], s[12:13], s34 offset:131264 glc
s_sub_u32 s33, s33, 1
s_cbranch_scc1 SE_56
s_waitcnt lgkmcnt(0)
s_and_b64 s[28:29], s[36:37], s[38:39]
s_or_b64 s[30:31], s[36:37], s[38:39]
s_and_b64 s[28:29], s[28:29], s[40:41]
s_or_b64 s[30:31], s[30:31], s[40:41]
s_and_b64 s[28:29], s[28:29], s[42:43]
s_or_b64 s[30:31], s[30:31], s[42:43]
s_and_b64 s[28:29], s[28:29], s[44:45]
s_or_b64 s[30:31], s[30:31], s[44:45]
s_and_b64 s[28:29], s[28:29], s[46:47]
s_or_b64 s[30:31], s[30:31], s[46:47]
s_and_b64 s[28:29], s[28:29], s[48:49]
s_or_b64 s[30:31], s[30:31], s[48:49]
s_and_b64 s[28:29], s[28:29], s[50:51]
s_or_b64 s[30:31], s[30:31], s[50:51]
s_and_b64 s[28:29], s[28:29], s[52:53]
s_or_b64 s[30:31], s[30:31], s[52:53]
s_and_b64 s[28:29], s[28:29], s[54:55]
s_or_b64 s[30:31], s[30:31], s[54:55]
s_and_b64 s[28:29], s[28:29], s[56:57]
s_or_b64 s[30:31], s[30:31], s[56:57]
s_and_b64 s[28:29], s[28:29], s[58:59]
s_or_b64 s[30:31], s[30:31], s[58:59]
s_and_b64 s[28:29], s[28:29], s[60:61]
s_or_b64 s[30:31], s[30:31], s[60:61]
s_and_b64 s[28:29], s[28:29], s[62:63]
s_or_b64 s[30:31], s[30:31], s[62:63]
s_and_b64 s[28:29], s[28:29], s[64:65]
s_or_b64 s[30:31], s[30:31], s[64:65]
s_and_b64 s[28:29], s[28:29], s[66:67]
s_or_b64 s[30:31], s[30:31], s[66:67]
s_and_b64 s[28:29], s[28:29], s[68:69]
s_or_b64 s[30:31], s[30:31], s[68:69]
s_and_b64 s[28:29], s[28:29], s[70:71]
s_or_b64 s[30:31], s[30:31], s[70:71]
s_and_b64 s[28:29], s[28:29], s[72:73]
s_or_b64 s[30:31], s[30:31], s[72:73]
s_and_b64 s[28:29], s[28:29], s[74:75]
s_or_b64 s[30:31], s[30:31], s[74:75]
s_and_b64 s[28:29], s[28:29], s[76:77]
s_or_b64 s[30:31], s[30:31], s[76:77]
s_and_b64 s[28:29], s[28:29], s[78:79]
s_or_b64 s[30:31], s[30:31], s[78:79]
s_and_b64 s[28:29], s[28:29], s[80:81]
s_or_b64 s[30:31], s[30:31], s[80:81]
s_and_b64 s[28:29], s[28:29], s[82:83]
s_or_b64 s[30:31], s[30:31], s[82:83]
s_and_b64 s[28:29], s[28:29], s[84:85]
s_or_b64 s[30:31], s[30:31], s[84:85]
s_and_b64 s[28:29], s[28:29], s[86:87]
s_or_b64 s[30:31], s[30:31], s[86:87]
s_and_b64 s[28:29], s[28:29], s[88:89]
s_or_b64 s[30:31], s[30:31], s[88:89]
s_and_b64 s[28:29], s[28:29], s[90:91]
s_or_b64 s[30:31], s[30:31], s[90:91]
s_and_b64 s[28:29], s[28:29], s[92:93]
s_or_b64 s[30:31], s[30:31], s[92:93]
s_and_b64 s[28:29], s[28:29], s[94:95]
s_or_b64 s[30:31], s[30:31], s[94:95]
s_and_b64 s[28:29], s[28:29], s[96:97]
s_or_b64 s[30:31], s[30:31], s[96:97]
s_and_b64 s[28:29], s[28:29], s[98:99]
s_or_b64 s[30:31], s[30:31], s[98:99]
s_xor_b32 s28, s28, s16
s_xor_b32 s29, s29, s35
s_xor_b32 s30, s30, s16
s_xor_b32 s31, s31, s35
s_or_b64 s[28:29], s[28:29], s[30:31]
s_or_b32 s28, s28, s29
s_and_b32 s28, s28, 0xffff
s_cbranch_scc1 SP_55
SE_56:
s_waitcnt lgkmcnt(0)
s_pack_hh_b32_b16 s36, s36, s37
s_pack_hh_b32_b16 s37, s38, s39
s_pack_hh_b32_b16 s38, s40, s41
s_pack_hh_b32_b16 s39, s42, s43
s_pack_hh_b32_b16 s40, s44, s45
s_pack_hh_b32_b16 s41, s46, s47
s_pack_hh_b32_b16 s42, s48, s49
s_pack_hh_b32_b16 s43, s50, s51
s_pack_hh_b32_b16 s44, s52, s53
s_pack_hh_b32_b16 s45, s54, s55
s_pack_hh_b32_b16 s46, s56, s57
s_pack_hh_b32_b16 s47, s58, s59
s_pack_hh_b32_b16 s48, s60, s61
s_pack_hh_b32_b16 s49, s62, s63
s_pack_hh_b32_b16 s50, s64, s65
s_pack_hh_b32_b16 s51, s66, s67
s_pack_hh_b32_b16 s52, s68, s69
s_pack_hh_b32_b16 s53, s70, s71
s_pack_hh_b32_b16 s54, s72, s73
s_pack_hh_b32_b16 s55, s74, s75
s_pack_hh_b32_b16 s56, s76, s77
s_pack_hh_b32_b16 s57, s78, s79
s_pack_hh_b32_b16 s58, s80, s81
s_pack_hh_b32_b16 s59, s82, s83
s_pack_hh_b32_b16 s60, s84, s85
s_pack_hh_b32_b16 s61, s86, s87
s_pack_hh_b32_b16 s62, s88, s89
s_pack_hh_b32_b16 s63, s90, s91
s_pack_hh_b32_b16 s64, s92, s93
s_pack_hh_b32_b16 s65, s94, s95
s_pack_hh_b32_b16 s66, s96, s97
s_pack_hh_b32_b16 s67, s98, s99
s_mov_b32 exec_lo, 0xffff
s_mov_b32 exec_hi, 0x0
v_mov_b32 v32, s36
v_mov_b32 v33, s37
v_mov_b32 v34, s38
v_mov_b32 v35, s39
v_mov_b32 v36, s52
v_mov_b32 v37, s53
v_mov_b32 v38, s54
v_mov_b32 v39, s55
s_mov_b32 exec_lo, 0xffff0000
s_mov_b32 exec_hi, 0x0
v_mov_b32 v32, s40
v_mov_b32 v33, s41
v_mov_b32 v34, s42
v_mov_b32 v35, s43
v_mov_b32 v36, s56
v_mov_b32 v37, s57
v_mov_b32 v38, s58
v_mov_b32 v39, s59
s_mov_b32 exec_lo, 0x0
s_mov_b32 exec_hi, 0xffff
v_mov_b32 v32, s44
v_mov_b32 v33, s45
v_mov_b32 v34, s46
v_mov_b32 v35, s47
v_mov_b32 v36, s60
v_mov_b32 v37, s61
v_mov_b32 v38, s62
v_mov_b32 v39, s63
s_mov_b32 exec_lo, 0x0
s_mov_b32 exec_hi, 0xffff0000
v_mov_b32 v32, s48
v_mov_b32 v33, s49
v_mov_b32 v34, s50
v_mov_b32 v35, s51
v_mov_b32 v36, s64
v_mov_b32 v37, s65
v_mov_b32 v38, s66
v_mov_b32 v39, s67
s_mov_b64 exec, -1
s_waitcnt vmcnt(0)
s_barrier
ds_read_b128 v[128:131], v25 offset:0
ds_read_b128 v[132:135], v26 offset:0
ds_read_b128 v[136:139], v25 offset:8192
ds_read_b128 v[140:143], v26 offset:8192
ds_read_b128 v[144:147], v25 offset:16384
ds_read_b128 v[148:151], v26 offset:16384
ds_read_b128 v[152:155], v25 offset:24576
ds_read_b128 v[156:159], v26 offset:24576
ds_read_b128 v[160:163], v25 offset:32768
ds_read_b128 v[164:167], v26 offset:32768
ds_read_b128 v[168:171], v25 offset:40960
ds_read_b128 v[172:175], v26 offset:40960
ds_read_b128 v[176:179], v25 offset:49152
ds_read_b128 v[180:183], v26 offset:49152
ds_read_b128 v[184:187], v25 offset:57344
ds_read_b128 v[188:191], v26 offset:57344
s_waitcnt lgkmcnt(14)
v_mfma_f32_16x16x32_bf16 v[40:43], v[128:131], v[32:35], 0
v_mfma_f32_16x16x32_bf16 v[40:43], v[132:135], v[36:39], v[40:43]
s_waitcnt lgkmcnt(12)
v_mfma_f32_16x16x32_bf16 v[44:47], v[136:139], v[32:35], 0
v_mfma_f32_16x16x32_bf16 v[44:47], v[140:143], v[36:39], v[44:47]
s_waitcnt lgkmcnt(10)
v_mfma_f32_16x16x32_bf16 v[48:51], v[144:147], v[32:35], 0
v_mfma_f32_16x16x32_bf16 v[48:51], v[148:151], v[36:39], v[48:51]
s_waitcnt lgkmcnt(8)
v_mfma_f32_16x16x32_bf16 v[52:55], v[152:155], v[32:35], 0
v_mfma_f32_16x16x32_bf16 v[52:55], v[156:159], v[36:39], v[52:55]
s_waitcnt lgkmcnt(6)
v_mfma_f32_16x16x32_bf16 v[56:59], v[160:163], v[32:35], 0
v_mfma_f32_16x16x32_bf16 v[56:59], v[164:167], v[36:39], v[56:59]
s_waitcnt lgkmcnt(4)
v_mfma_f32_16x16x32_bf16 v[60:63], v[168:171], v[32:35], 0
v_mfma_f32_16x16x32_bf16 v[60:63], v[172:175], v[36:39], v[60:63]
s_waitcnt lgkmcnt(2)
v_mfma_f32_16x16x32_bf16 v[64:67], v[176:179], v[32:35], 0
v_mfma_f32_16x16x32_bf16 v[64:67], v[180:183], v[36:39], v[64:67]
s_waitcnt lgkmcnt(0)
v_mfma_f32_16x16x32_bf16 v[68:71], v[184:187], v[32:35], 0
v_mfma_f32_16x16x32_bf16 v[68:71], v[188:191], v[36:39], v[68:71]
s_mov_b32 exec_lo, 0x00010001
s_mov_b32 exec_hi, 0x00010001
ds_write_b128 v24, v[40:43] offset:0
ds_write_b128 v24, v[44:47] offset:64
ds_write_b128 v24, v[48:51] offset:128
ds_write_b128 v24, v[52:55] offset:192
ds_write_b128 v24, v[56:59] offset:256
ds_write_b128 v24, v[60:63] offset:320
ds_write_b128 v24, v[64:67] offset:384
ds_write_b128 v24, v[68:71] offset:448
s_mov_b64 exec, -1
s_waitcnt lgkmcnt(0)
s_barrier
s_setprio 0
v_lshrrev_b32 v95, 5, v1
v_lshlrev_b32 v94, 2, v95
v_and_b32 v92, 31, v1
v_xor_b32 v92, v92, v94
v_lshlrev_b32 v92, 4, v92
v_lshl_add_u32 v92, v95, 9, v92
v_xor_b32 v224, 0, v92
v_xor_b32 v225, 1152, v92
v_xor_b32 v226, 2064, v92
v_xor_b32 v227, 3216, v92
v_xor_b32 v228, 4128, v92
v_xor_b32 v229, 5280, v92
v_xor_b32 v230, 6192, v92
v_xor_b32 v231, 7344, v92
s_lshl_b32 s47, s3, 14
s_add_u32 s47, s47, 16384
v_and_b32 v94, 3, v1
v_lshlrev_b32 v94, 2, v94
v_bfe_u32 v95, v1, 2, 2
v_add_u32 v94, v94, v95
v_lshlrev_b32 v92, 9, v94
v_lshrrev_b32 v95, 4, v1
v_and_b32 v94, 15, v1
v_xor_b32 v93, v95, v94
v_lshl_add_u32 v92, v93, 4, v92
v_add_u32 v92, s47, v92
v_xor_b32 v232, 0, v92
v_xor_b32 v233, 64, v92
v_xor_b32 v234, 128, v92
v_xor_b32 v235, 192, v92
v_lshlrev_b32 v93, 9, v95
v_lshl_add_u32 v93, v94, 4, v93
v_add_u32 v94, 0x1000, v93
v_readfirstlane_b32 s31, v0
s_nop 0
s_and_b32 s45, s31, 7
s_lshr_b32 s48, s31, 3
s_lshr_b32 s28, s31, 6
s_add_u32 s48, s48, s28
s_add_u32 s48, s48, s3
s_and_b32 s48, s48, 3
s_lshl_b32 s49, s45, 2
s_add_u32 s49, s49, s48
s_lshl_b32 s49, s49, 7
s_mul_i32 s58, s45, 0
s_mul_i32 s28, s48, 0
s_add_u32 s58, s58, s28
s_lshl_b32 s45, s45, 22
s_mov_b32 s46, 0x3db8aa3b
s_add_u32 s4, s20, s45
s_addc_u32 s5, s21, 0
s_mov_b32 s6, 4194304
s_mov_b32 s7, 0x00020000
s_add_u32 s8, s22, s45
s_addc_u32 s9, s23, 0
s_mov_b32 s10, 4194304
s_mov_b32 s11, 0x00020000
s_load_dwordx4 s[68:71], s[0:1], 72
s_lshl_b32 s48, s48, 13
s_mov_b32 s52, 16
v_mov_b32 v26, 0xf149f2ca
v_mov_b32 v27, 0
v_mov_b32 v64, 0
v_mov_b32 v65, 0
v_mov_b32 v66, 0
v_mov_b32 v67, 0
v_mov_b32 v68, 0
v_mov_b32 v69, 0
v_mov_b32 v70, 0
v_mov_b32 v71, 0
v_bfe_u32 v103, v1, 3, 1
v_lshlrev_b32 v103, 14, v103
v_lshrrev_b32 v23, 5, v1
v_lshl_add_u32 v103, v23, 12, v103
v_bfe_u32 v23, v1, 4, 1
v_lshl_add_u32 v103, v23, 6, v103
v_and_b32 v23, 7, v1
v_lshl_add_u32 v103, v23, 3, v103
v_add_u32 v104, 0x2000, v103
s_lshr_b32 s34, s31, 3
s_and_b32 s35, s31, 7
s_and_b32 s56, s2, 7
s_lshl_b32 s56, s56, 3
s_lshr_b32 s28, s2, 5
s_add_u32 s56, s56, s28
s_lshl_b32 s38, s35, 15
s_lshl_b32 s28, s34, 7
s_add_u32 s38, s38, s28
s_add_u32 s38, s38, 458752
s_lshl_b32 s39, s35, 9
s_lshl_b32 s28, s34, 3
s_add_u32 s39, s39, s28
s_add_u32 s39, s39, 983040
v_lshrrev_b32 v105, 4, v1
v_lshlrev_b32 v105, 12, v105
v_bfe_u32 v23, v1, 3, 1
v_lshl_add_u32 v105, v23, 8, v105
v_and_b32 v23, 3, v1
v_lshl_add_u32 v105, v23, 14, v105
v_and_b32 v23, 7, v1
v_lshlrev_b32 v23, 2, v23
v_lshrrev_b32 v23, v23, s16
v_bfe_u32 v24, v23, 1, 1
v_bfe_u32 v242, v23, 0, 1
v_lshl_or_b32 v242, v24, 16, v242
v_bfe_u32 v24, v23, 3, 1
v_bfe_u32 v243, v23, 2, 1
v_lshl_or_b32 v243, v24, 16, v243
v_add_u32 v101, 147456, v18
v_and_b32 v102, 15, v1
v_lshlrev_b32 v102, 3, v102
v_add_u32 v102, 161792, v102
s_lshl_b32 s28, s3, 11
v_add_u32 v240, s28, v101
s_lshl_b32 s28, s3, 7
v_add_u32 v241, s28, v102
v_bfe_u32 v96, s16, 0, 8
v_bfe_u32 v97, s16, 8, 8
v_bfe_u32 v98, s16, 16, 8
v_bfe_u32 v99, s16, 24, 8
s_and_b32 s60, s56, 0
s_lshl_b32 s60, s60, 2
s_add_u32 s60, s60, s101
s_lshl_b32 s60, s60, 12
s_lshr_b32 s28, s56, 2
s_lshl_b32 s28, s28, 8
s_add_u32 s60, s60, s28
s_lshl_b32 s40, s56, 12
s_add_u32 s40, s40, 458752
v_lshrrev_b32 v106, 4, v1
v_bfe_u32 v23, v1, 2, 2
v_and_b32 v24, 3, v1
v_lshl_add_u32 v107, v106, 3, v23
v_lshlrev_b32 v107, 7, v107
v_lshl_add_u32 v107, v24, 3, v107
v_add_u32 v107, 81920, v107
v_lshl_add_u32 v108, v23, 3, v106
v_lshlrev_b32 v108, 8, v108
v_lshl_add_u32 v108, v24, 3, v108
v_lshl_add_u32 v108, v23, 6, v108
v_and_b32 v24, 1, v106
v_lshl_add_u32 v108, v24, 5, v108
v_lshrrev_b32 v110, 4, v1
v_mul_u32_u24 v109, 7168, v110
v_and_b32 v111, 1, v110
v_lshrrev_b32 v110, 1, v110
v_lshl_add_u32 v110, v110, 3, v111
v_mul_u32_u24 v110, 3584, v110
v_and_b32 v23, 15, v1
v_lshl_add_u32 v109, v23, 4, v109
v_lshl_add_u32 v110, v23, 4, v110
v_mov_b32 v24, 0x7ff00000
s_cmp_eq_u32 s101, 3
s_cselect_b32 s28, 8, 16
v_lshrrev_b32 v109, 4, v1
v_and_b32 v25, 1, v109
v_lshlrev_b32 v25, 1, v25
v_xor_b32 v25, v25, v23
v_mul_u32_u24 v109, 896, v109
v_xor_b32 v28, 0, v25
v_lshl_add_u32 v236, v28, 4, v109
v_cmp_le_u32 vcc, s28, v28
s_nop 1
v_cndmask_b32 v236, v236, v24, vcc
v_xor_b32 v28, 4, v25
v_lshl_add_u32 v237, v28, 4, v109
v_cmp_le_u32 vcc, s28, v28
s_nop 1
v_cndmask_b32 v237, v237, v24, vcc
v_xor_b32 v28, 8, v25
v_lshl_add_u32 v238, v28, 4, v109
v_cmp_le_u32 vcc, s28, v28
s_nop 1
v_cndmask_b32 v238, v238, v24, vcc
v_xor_b32 v28, 12, v25
v_lshl_add_u32 v239, v28, 4, v109
v_cmp_le_u32 vcc, s28, v28
s_nop 1
v_cndmask_b32 v239, v239, v24, vcc
s_and_b32 s29, s2, 3
s_cmp_eq_u32 s29, 3
s_cselect_b32 s28, 8, 16
v_cmp_le_u32 vcc, s28, v23
s_nop 1
v_cndmask_b32 v110, v110, v24, vcc
s_mul_i32 s42, s56, 57344
s_lshl_b32 s28, s101, 8
s_add_u32 s42, s42, s28
s_lshr_b32 s43, s2, 2
s_mul_i32 s43, s43, 57344
s_lshl_b32 s28, s29, 8
s_add_u32 s43, s43, s28
s_lshr_b32 s44, s31, 3
s_mul_i32 s30, s44, 37
s_add_u32 s30, s30, s58
s_and_b32 s30, s30, 127
s_lshl_b32 s30, s30, 15
s_add_u32 s30, s30, s48
s_add_u32 m0, s47, 8192
s_nop 0
buffer_load_dwordx4 v224, s[4:7], s30 offen nt lds
s_add_u32 m0, s47, 9216
s_nop 0
buffer_load_dwordx4 v225, s[4:7], s30 offen nt lds
s_add_u32 m0, s47, 10240
s_nop 0
buffer_load_dwordx4 v226, s[4:7], s30 offen nt lds
s_add_u32 m0, s47, 11264
s_nop 0
buffer_load_dwordx4 v227, s[4:7], s30 offen nt lds
s_waitcnt vmcnt(3)
s_add_u32 m0, s47, 12288
s_nop 0
buffer_load_dwordx4 v228, s[4:7], s30 offen nt lds
s_waitcnt vmcnt(3)
s_add_u32 m0, s47, 13312
s_nop 0
buffer_load_dwordx4 v229, s[4:7], s30 offen nt lds
s_waitcnt lgkmcnt(0)
s_mov_b64 exec, 1
ds_add_u32 v2, v3 offset:52
s_mov_b64 exec, -1
s_add_u32 m0, s47, 14336
s_nop 0
buffer_load_dwordx4 v230, s[4:7], s30 offen nt lds
s_add_u32 m0, s47, 15360
s_nop 0
buffer_load_dwordx4 v231, s[4:7], s30 offen nt lds
s_waitcnt vmcnt(7)
buffer_load_dwordx4 v[160:163], v93, s[8:11], s30 offen offset:0 nt
s_waitcnt vmcnt(7)
buffer_load_dwordx4 v[164:167], v93, s[8:11], s30 offen offset:256 nt
s_waitcnt vmcnt(7)
buffer_load_dwordx4 v[168:171], v93, s[8:11], s30 offen offset:2048 nt
s_waitcnt vmcnt(7)
buffer_load_dwordx4 v[172:175], v93, s[8:11], s30 offen offset:2304 nt
s_waitcnt vmcnt(7)
buffer_load_dwordx4 v[176:179], v94, s[8:11], s30 offen offset:0 nt
s_waitcnt vmcnt(7)
buffer_load_dwordx4 v[180:183], v94, s[8:11], s30 offen offset:256 nt
s_waitcnt vmcnt(7)
buffer_load_dwordx4 v[184:187], v94, s[8:11], s30 offen offset:2048 nt
s_waitcnt vmcnt(7)
buffer_load_dwordx4 v[188:191], v94, s[8:11], s30 offen offset:2304 nt
s_add_u32 s44, s44, 24
s_mul_i32 s30, s44, 37
s_add_u32 s30, s30, s58
s_and_b32 s30, s30, 127
s_lshl_b32 s30, s30, 15
s_add_u32 s30, s30, s48
s_waitcnt vmcnt(7)
s_add_u32 m0, s47, 0
s_nop 0
buffer_load_dwordx4 v224, s[4:7], s30 offen nt lds
s_waitcnt vmcnt(7)
s_add_u32 m0, s47, 1024
s_nop 0
buffer_load_dwordx4 v225, s[4:7], s30 offen nt lds
s_waitcnt vmcnt(7)
s_add_u32 m0, s47, 2048
s_nop 0
buffer_load_dwordx4 v226, s[4:7], s30 offen nt lds
s_waitcnt vmcnt(7)
s_add_u32 m0, s47, 3072
s_nop 0
buffer_load_dwordx4 v227, s[4:7], s30 offen nt lds
s_waitcnt vmcnt(7)
s_add_u32 m0, s47, 4096
s_nop 0
buffer_load_dwordx4 v228, s[4:7], s30 offen nt lds
s_waitcnt vmcnt(7)
s_add_u32 m0, s47, 5120
s_nop 0
buffer_load_dwordx4 v229, s[4:7], s30 offen nt lds
s_waitcnt vmcnt(7)
s_add_u32 m0, s47, 6144
s_nop 0
buffer_load_dwordx4 v230, s[4:7], s30 offen nt lds
s_waitcnt vmcnt(7)
s_add_u32 m0, s47, 7168
s_nop 0
buffer_load_dwordx4 v231, s[4:7], s30 offen nt lds
s_waitcnt vmcnt(7)
buffer_load_dwordx4 v[128:131], v93, s[8:11], s30 offen offset:0 nt
s_waitcnt vmcnt(7)
buffer_load_dwordx4 v[132:135], v93, s[8:11], s30 offen offset:256 nt
s_waitcnt vmcnt(7)
buffer_load_dwordx4 v[136:139], v93, s[8:11], s30 offen offset:2048 nt
s_waitcnt vmcnt(7)
buffer_load_dwordx4 v[140:143], v93, s[8:11], s30 offen offset:2304 nt
s_waitcnt vmcnt(7)
buffer_load_dwordx4 v[144:147], v94, s[8:11], s30 offen offset:0 nt
s_waitcnt vmcnt(7)
buffer_load_dwordx4 v[148:151], v94, s[8:11], s30 offen offset:256 nt
s_waitcnt vmcnt(7)
buffer_load_dwordx4 v[152:155], v94, s[8:11], s30 offen offset:2048 nt
s_waitcnt vmcnt(7)
buffer_load_dwordx4 v[156:159], v94, s[8:11], s30 offen offset:2304 nt
s_branch S_pro
S_P:
v_mov_b32 v12, 0
v_mov_b32 v2, 163072
v_mov_b32 v3, 1
s_bfe_u32 s101, s2, 0x20003
s_and_b32 s28, s2, 7
s_and_b32 s31, s2, 0xc0
s_lshl_b32 s28, s28, 3
s_add_u32 s31, s31, s28
s_bfe_u32 s28, s2, 0x30003
s_add_u32 s31, s31, s28
v_mov_b32 v0, s31
v_mov_b32 v13, 0
v_lshl_add_u32 v14, v1, 2, v2
s_mov_b32 exec_hi, 0
ds_write_b32 v14, v13
s_mov_b64 exec, -1
v_lshlrev_b32 v18, 4, v1
s_waitcnt lgkmcnt(0)
s_mov_b32 s12, s62
s_mov_b32 s13, s63
s_mov_b32 s14, 3407872
s_mov_b32 s15, 0x00020000
s_load_dword s16, s[12:13], 0
s_mov_b64 s[26:27], s[58:59]
s_mov_b64 s[20:21], s[38:39]
s_mov_b64 s[22:23], s[40:41]
s_mov_b64 s[24:25], s[44:45]
v_lshrrev_b32 v95, 5, v1
v_lshlrev_b32 v94, 2, v95
v_and_b32 v92, 31, v1
v_xor_b32 v92, v92, v94
v_lshlrev_b32 v92, 4, v92
v_lshl_add_u32 v92, v95, 9, v92
v_xor_b32 v224, 0, v92
v_xor_b32 v225, 1152, v92
v_xor_b32 v226, 2064, v92
v_xor_b32 v227, 3216, v92
v_xor_b32 v228, 4128, v92
v_xor_b32 v229, 5280, v92
v_xor_b32 v230, 6192, v92
v_xor_b32 v231, 7344, v92
s_lshl_b32 s47, s3, 14
s_add_u32 s47, s47, 16384
v_and_b32 v94, 3, v1
v_lshlrev_b32 v94, 2, v94
v_bfe_u32 v95, v1, 2, 2
v_add_u32 v94, v94, v95
v_lshlrev_b32 v92, 9, v94
v_lshrrev_b32 v95, 4, v1
v_and_b32 v94, 15, v1
v_xor_b32 v93, v95, v94
v_lshl_add_u32 v92, v93, 4, v92
v_add_u32 v92, s47, v92
v_xor_b32 v232, 0, v92
v_xor_b32 v233, 64, v92
v_xor_b32 v234, 128, v92
v_xor_b32 v235, 192, v92
v_lshlrev_b32 v93, 9, v95
v_lshl_add_u32 v93, v94, 4, v93
v_add_u32 v94, 0x1000, v93
v_readfirstlane_b32 s31, v0
s_nop 0
s_and_b32 s45, s31, 7
s_lshr_b32 s48, s31, 3
s_lshr_b32 s28, s31, 6
s_add_u32 s48, s48, s28
s_add_u32 s48, s48, s3
s_and_b32 s48, s48, 3
s_lshl_b32 s49, s45, 2
s_add_u32 s49, s49, s48
s_lshl_b32 s49, s49, 7
s_mul_i32 s58, s45, 0
s_mul_i32 s28, s48, 0
s_add_u32 s58, s58, s28
s_lshl_b32 s45, s45, 22
s_mov_b32 s46, 0x3db8aa3b
s_add_u32 s4, s20, s45
s_addc_u32 s5, s21, 0
s_mov_b32 s6, 4194304
s_mov_b32 s7, 0x00020000
s_add_u32 s8, s22, s45
s_addc_u32 s9, s23, 0
s_mov_b32 s10, 4194304
s_mov_b32 s11, 0x00020000
s_load_dwordx4 s[68:71], s[0:1], 72
s_lshl_b32 s48, s48, 13
s_mov_b32 s52, 16
v_mov_b32 v26, 0xf149f2ca
v_mov_b32 v27, 0
v_mov_b32 v64, 0
v_mov_b32 v65, 0
v_mov_b32 v66, 0
v_mov_b32 v67, 0
v_mov_b32 v68, 0
v_mov_b32 v69, 0
v_mov_b32 v70, 0
v_mov_b32 v71, 0
s_lshr_b32 s44, s31, 3
s_cmp_lt_u32 s2, 64
s_cbranch_scc1 S_P0
s_mul_i32 s30, s44, 37
s_add_u32 s30, s30, s58
s_and_b32 s30, s30, 127
s_lshl_b32 s30, s30, 15
s_add_u32 s30, s30, s48
v_and_b32 v13, 1, v1
v_cmp_eq_u32 vcc, 1, v13
v_mov_b32 v14, 0x0c0c0100
v_mov_b32 v15, 0x01000c0c
v_cndmask_b32 v14, v14, v15, vcc
v_mov_b32 v31, 0x0c0c0302
v_mov_b32 v15, 0x03020c0c
v_cndmask_b32 v15, v31, v15, vcc
v_bfe_u32 v13, v1, 1, 2
v_mov_b32 v31, 0x0c0c0c0c
v_cmp_eq_u32 vcc, 0, v13
s_nop 1
v_cndmask_b32 v4, v31, v14, vcc
v_cndmask_b32 v8, v31, v15, vcc
v_cmp_eq_u32 vcc, 1, v13
s_nop 1
v_cndmask_b32 v5, v31, v14, vcc
v_cndmask_b32 v9, v31, v15, vcc
v_cmp_eq_u32 vcc, 2, v13
s_nop 1
v_cndmask_b32 v6, v31, v14, vcc
v_cndmask_b32 v10, v31, v15, vcc
v_cmp_eq_u32 vcc, 3, v13
s_nop 1
v_cndmask_b32 v7, v31, v14, vcc
v_cndmask_b32 v11, v31, v15, vcc
v_mov_b32 v16, 0x07060302
v_mov_b32 v17, 0xfffefffe
v_mov_b32 v19, 0xffffff00
s_waitcnt lgkmcnt(0)
s_add_u32 s16, s16, 0x01010101
s_and_b32 s17, s16, 0xff
s_bfe_u32 s18, s16, 0x80010
s_mov_b32 s63, s30
v_bfe_u32 v103, v1, 3, 1
v_lshlrev_b32 v103, 14, v103
v_lshrrev_b32 v23, 5, v1
v_lshl_add_u32 v103, v23, 12, v103
v_bfe_u32 v23, v1, 4, 1
v_lshl_add_u32 v103, v23, 6, v103
v_and_b32 v23, 7, v1
v_lshl_add_u32 v103, v23, 3, v103
v_add_u32 v104, 0x2000, v103
s_lshr_b32 s34, s31, 3
s_and_b32 s35, s31, 7
s_and_b32 s56, s2, 7
s_lshl_b32 s56, s56, 3
s_lshr_b32 s28, s2, 5
s_add_u32 s56, s56, s28
s_lshl_b32 s38, s35, 15
s_lshl_b32 s28, s34, 7
s_add_u32 s38, s38, s28
s_add_u32 s38, s38, 458752
s_lshl_b32 s39, s35, 9
s_lshl_b32 s28, s34, 3
s_add_u32 s39, s39, s28
s_add_u32 s39, s39, 983040
v_lshrrev_b32 v105, 4, v1
v_lshlrev_b32 v105, 12, v105
v_bfe_u32 v23, v1, 3, 1
v_lshl_add_u32 v105, v23, 8, v105
v_and_b32 v23, 3, v1
v_lshl_add_u32 v105, v23, 14, v105
v_and_b32 v23, 7, v1
v_lshlrev_b32 v23, 2, v23
v_lshrrev_b32 v23, v23, s16
v_bfe_u32 v24, v23, 1, 1
v_bfe_u32 v242, v23, 0, 1
v_lshl_or_b32 v242, v24, 16, v242
v_bfe_u32 v24, v23, 3, 1
v_bfe_u32 v243, v23, 2, 1
v_lshl_or_b32 v243, v24, 16, v243
v_add_u32 v101, 147456, v18
v_and_b32 v102, 15, v1
v_lshlrev_b32 v102, 3, v102
v_add_u32 v102, 161792, v102
s_lshl_b32 s28, s3, 11
v_add_u32 v240, s28, v101
s_lshl_b32 s28, s3, 7
v_add_u32 v241, s28, v102
v_bfe_u32 v96, s16, 0, 8
v_bfe_u32 v97, s16, 8, 8
v_bfe_u32 v98, s16, 16, 8
v_bfe_u32 v99, s16, 24, 8
s_and_b32 s60, s56, 0
s_lshl_b32 s60, s60, 2
s_add_u32 s60, s60, s101
s_lshl_b32 s60, s60, 12
s_lshr_b32 s28, s56, 2
s_lshl_b32 s28, s28, 8
s_add_u32 s60, s60, s28
s_lshl_b32 s40, s56, 12
s_add_u32 s40, s40, 458752
v_lshrrev_b32 v106, 4, v1
v_bfe_u32 v23, v1, 2, 2
v_and_b32 v24, 3, v1
v_lshl_add_u32 v107, v106, 3, v23
v_lshlrev_b32 v107, 7, v107
v_lshl_add_u32 v107, v24, 3, v107
v_add_u32 v107, 81920, v107
v_lshl_add_u32 v108, v23, 3, v106
v_lshlrev_b32 v108, 8, v108
v_lshl_add_u32 v108, v24, 3, v108
v_lshl_add_u32 v108, v23, 6, v108
v_and_b32 v24, 1, v106
v_lshl_add_u32 v108, v24, 5, v108
v_lshrrev_b32 v110, 4, v1
v_mul_u32_u24 v109, 7168, v110
v_and_b32 v111, 1, v110
v_lshrrev_b32 v110, 1, v110
v_lshl_add_u32 v110, v110, 3, v111
v_mul_u32_u24 v110, 3584, v110
v_and_b32 v23, 15, v1
v_lshl_add_u32 v109, v23, 4, v109
v_lshl_add_u32 v110, v23, 4, v110
v_mov_b32 v24, 0x7ff00000
s_cmp_eq_u32 s101, 3
s_cselect_b32 s28, 8, 16
v_lshrrev_b32 v109, 4, v1
v_and_b32 v25, 1, v109
v_lshlrev_b32 v25, 1, v25
v_xor_b32 v25, v25, v23
v_mul_u32_u24 v109, 896, v109
v_xor_b32 v28, 0, v25
v_lshl_add_u32 v236, v28, 4, v109
v_cmp_le_u32 vcc, s28, v28
s_nop 1
v_cndmask_b32 v236, v236, v24, vcc
v_xor_b32 v28, 4, v25
v_lshl_add_u32 v237, v28, 4, v109
v_cmp_le_u32 vcc, s28, v28
s_nop 1
v_cndmask_b32 v237, v237, v24, vcc
v_xor_b32 v28, 8, v25
v_lshl_add_u32 v238, v28, 4, v109
v_cmp_le_u32 vcc, s28, v28
s_nop 1
v_cndmask_b32 v238, v238, v24, vcc
v_xor_b32 v28, 12, v25
v_lshl_add_u32 v239, v28, 4, v109
v_cmp_le_u32 vcc, s28, v28
s_nop 1
v_cndmask_b32 v239, v239, v24, vcc
s_and_b32 s29, s2, 3
s_cmp_eq_u32 s29, 3
s_cselect_b32 s28, 8, 16
v_cmp_le_u32 vcc, s28, v23
s_nop 1
v_cndmask_b32 v110, v110, v24, vcc
s_mul_i32 s42, s56, 57344
s_lshl_b32 s28, s101, 8
s_add_u32 s42, s42, s28
s_lshr_b32 s43, s2, 2
s_mul_i32 s43, s43, 57344
s_lshl_b32 s28, s29, 8
s_add_u32 s43, s43, s28
s_cmp_lg_u32 s44, 0
s_cbranch_scc1 NI_57
v_mov_b32 v28, 48
v_mov_b32 v29, s16
v_mov_b32 v30, 0
s_add_u32 s28, s49, 319488
s_mov_b64 exec, 1
buffer_store_dwordx2 v[28:29], v30, s[12:15], s28 offen sc1
s_mov_b64 exec, -1
NI_57:
s_barrier
s_add_u32 m0, s47, 8192
s_nop 0
buffer_load_dwordx4 v224, s[4:7], s30 offen nt lds
s_add_u32 m0, s47, 9216
s_nop 0
buffer_load_dwordx4 v225, s[4:7], s30 offen nt lds
s_add_u32 m0, s47, 10240
s_nop 0
buffer_load_dwordx4 v226, s[4:7], s30 offen nt lds
s_add_u32 m0, s47, 11264
s_nop 0
buffer_load_dwordx4 v227, s[4:7], s30 offen nt lds
s_waitcnt vmcnt(3)
s_add_u32 m0, s47, 12288
s_nop 0
buffer_load_dwordx4 v228, s[4:7], s30 offen nt lds
s_waitcnt vmcnt(3)
s_add_u32 m0, s47, 13312
s_nop 0
buffer_load_dwordx4 v229, s[4:7], s30 offen nt lds
s_waitcnt vmcnt(3)
s_add_u32 m0, s47, 14336
s_nop 0
buffer_load_dwordx4 v230, s[4:7], s30 offen nt lds
s_waitcnt vmcnt(3)
s_add_u32 m0, s47, 15360
s_nop 0
buffer_load_dwordx4 v231, s[4:7], s30 offen nt lds
s_waitcnt vmcnt(3)
buffer_load_dwordx4 v[160:163], v93, s[8:11], s30 offen offset:0 nt
s_waitcnt vmcnt(3)
buffer_load_dwordx4 v[164:167], v93, s[8:11], s30 offen offset:256 nt
s_waitcnt lgkmcnt(0)
s_mov_b64 exec, 1
ds_add_u32 v2, v3 offset:52
s_mov_b64 exec, -1
s_waitcnt vmcnt(7)
buffer_load_dwordx4 v[168:171], v93, s[8:11], s30 offen offset:2048 nt
s_waitcnt vmcnt(7)
buffer_load_dwordx4 v[172:175], v93, s[8:11], s30 offen offset:2304 nt
s_waitcnt vmcnt(7)
buffer_load_dwordx4 v[176:179], v94, s[8:11], s30 offen offset:0 nt
s_waitcnt vmcnt(7)
buffer_load_dwordx4 v[180:183], v94, s[8:11], s30 offen offset:256 nt
s_waitcnt vmcnt(7)
buffer_load_dwordx4 v[184:187], v94, s[8:11], s30 offen offset:2048 nt
s_waitcnt vmcnt(7)
buffer_load_dwordx4 v[188:191], v94, s[8:11], s30 offen offset:2304 nt
s_add_u32 s44, s44, 24
s_mul_i32 s30, s44, 37
s_add_u32 s30, s30, s58
s_and_b32 s30, s30, 127
s_lshl_b32 s30, s30, 15
s_add_u32 s30, s30, s48
s_waitcnt vmcnt(7)
s_add_u32 m0, s47, 0
s_nop 0
buffer_load_dwordx4 v224, s[4:7], s30 offen nt lds
s_waitcnt vmcnt(7)
s_add_u32 m0, s47, 1024
s_nop 0
buffer_load_dwordx4 v225, s[4:7], s30 offen nt lds
s_waitcnt vmcnt(7)
s_add_u32 m0, s47, 2048
s_nop 0
buffer_load_dwordx4 v226, s[4:7], s30 offen nt lds
s_waitcnt vmcnt(7)
s_add_u32 m0, s47, 3072
s_nop 0
buffer_load_dwordx4 v227, s[4:7], s30 offen nt lds
s_waitcnt vmcnt(7)
s_add_u32 m0, s47, 4096
s_nop 0
buffer_load_dwordx4 v228, s[4:7], s30 offen nt lds
s_waitcnt vmcnt(7)
s_add_u32 m0, s47, 5120
s_nop 0
buffer_load_dwordx4 v229, s[4:7], s30 offen nt lds
s_waitcnt vmcnt(7)
s_add_u32 m0, s47, 6144
s_nop 0
buffer_load_dwordx4 v230, s[4:7], s30 offen nt lds
s_waitcnt vmcnt(7)
s_add_u32 m0, s47, 7168
s_nop 0
buffer_load_dwordx4 v231, s[4:7], s30 offen nt lds
s_waitcnt vmcnt(7)
buffer_load_dwordx4 v[128:131], v93, s[8:11], s30 offen offset:0 nt
s_waitcnt vmcnt(7)
buffer_load_dwordx4 v[132:135], v93, s[8:11], s30 offen offset:256 nt
s_waitcnt vmcnt(7)
buffer_load_dwordx4 v[136:139], v93, s[8:11], s30 offen offset:2048 nt
s_waitcnt vmcnt(7)
buffer_load_dwordx4 v[140:143], v93, s[8:11], s30 offen offset:2304 nt
s_waitcnt vmcnt(7)
buffer_load_dwordx4 v[144:147], v94, s[8:11], s30 offen offset:0 nt
s_waitcnt vmcnt(7)
buffer_load_dwordx4 v[148:151], v94, s[8:11], s30 offen offset:256 nt
s_waitcnt vmcnt(7)
buffer_load_dwordx4 v[152:155], v94, s[8:11], s30 offen offset:2048 nt
s_waitcnt vmcnt(7)
buffer_load_dwordx4 v[156:159], v94, s[8:11], s30 offen offset:2304 nt
s_branch S_pro
S_P0:
s_mul_i32 s30, s44, 37
s_add_u32 s30, s30, s58
s_and_b32 s30, s30, 127
s_lshl_b32 s30, s30, 15
s_add_u32 s30, s30, s48
v_and_b32 v13, 1, v1
v_cmp_eq_u32 vcc, 1, v13
v_mov_b32 v14, 0x0c0c0100
v_mov_b32 v15, 0x01000c0c
v_cndmask_b32 v14, v14, v15, vcc
v_mov_b32 v31, 0x0c0c0302
v_mov_b32 v15, 0x03020c0c
v_cndmask_b32 v15, v31, v15, vcc
v_bfe_u32 v13, v1, 1, 2
v_mov_b32 v31, 0x0c0c0c0c
v_cmp_eq_u32 vcc, 0, v13
s_nop 1
v_cndmask_b32 v4, v31, v14, vcc
v_cndmask_b32 v8, v31, v15, vcc
v_cmp_eq_u32 vcc, 1, v13
s_nop 1
v_cndmask_b32 v5, v31, v14, vcc
v_cndmask_b32 v9, v31, v15, vcc
v_cmp_eq_u32 vcc, 2, v13
s_nop 1
v_cndmask_b32 v6, v31, v14, vcc
v_cndmask_b32 v10, v31, v15, vcc
v_cmp_eq_u32 vcc, 3, v13
s_nop 1
v_cndmask_b32 v7, v31, v14, vcc
v_cndmask_b32 v11, v31, v15, vcc
v_mov_b32 v16, 0x07060302
v_mov_b32 v17, 0xfffefffe
v_mov_b32 v19, 0xffffff00
s_waitcnt lgkmcnt(0)
s_add_u32 s16, s16, 0x01010101
s_and_b32 s17, s16, 0xff
s_bfe_u32 s18, s16, 0x80010
s_mov_b32 s63, s30
v_bfe_u32 v103, v1, 3, 1
v_lshlrev_b32 v103, 14, v103
v_lshrrev_b32 v23, 5, v1
v_lshl_add_u32 v103, v23, 12, v103
v_bfe_u32 v23, v1, 4, 1
v_lshl_add_u32 v103, v23, 6, v103
v_and_b32 v23, 7, v1
v_lshl_add_u32 v103, v23, 3, v103
v_add_u32 v104, 0x2000, v103
s_lshr_b32 s34, s31, 3
s_and_b32 s35, s31, 7
s_and_b32 s56, s2, 7
s_lshl_b32 s56, s56, 3
s_lshr_b32 s28, s2, 5
s_add_u32 s56, s56, s28
s_lshl_b32 s38, s35, 15
s_lshl_b32 s28, s34, 7
s_add_u32 s38, s38, s28
s_add_u32 s38, s38, 458752
s_lshl_b32 s39, s35, 9
s_lshl_b32 s28, s34, 3
s_add_u32 s39, s39, s28
s_add_u32 s39, s39, 983040
v_lshrrev_b32 v105, 4, v1
v_lshlrev_b32 v105, 12, v105
v_bfe_u32 v23, v1, 3, 1
v_lshl_add_u32 v105, v23, 8, v105
v_and_b32 v23, 3, v1
v_lshl_add_u32 v105, v23, 14, v105
v_and_b32 v23, 7, v1
v_lshlrev_b32 v23, 2, v23
v_lshrrev_b32 v23, v23, s16
v_bfe_u32 v24, v23, 1, 1
v_bfe_u32 v242, v23, 0, 1
v_lshl_or_b32 v242, v24, 16, v242
v_bfe_u32 v24, v23, 3, 1
v_bfe_u32 v243, v23, 2, 1
v_lshl_or_b32 v243, v24, 16, v243
v_add_u32 v101, 147456, v18
v_and_b32 v102, 15, v1
v_lshlrev_b32 v102, 3, v102
v_add_u32 v102, 161792, v102
s_lshl_b32 s28, s3, 11
v_add_u32 v240, s28, v101
s_lshl_b32 s28, s3, 7
v_add_u32 v241, s28, v102
v_bfe_u32 v96, s16, 0, 8
v_bfe_u32 v97, s16, 8, 8
v_bfe_u32 v98, s16, 16, 8
v_bfe_u32 v99, s16, 24, 8
s_and_b32 s60, s56, 0
s_lshl_b32 s60, s60, 2
s_add_u32 s60, s60, s101
s_lshl_b32 s60, s60, 12
s_lshr_b32 s28, s56, 2
s_lshl_b32 s28, s28, 8
s_add_u32 s60, s60, s28
s_lshl_b32 s40, s56, 12
s_add_u32 s40, s40, 458752
v_lshrrev_b32 v106, 4, v1
v_bfe_u32 v23, v1, 2, 2
v_and_b32 v24, 3, v1
v_lshl_add_u32 v107, v106, 3, v23
v_lshlrev_b32 v107, 7, v107
v_lshl_add_u32 v107, v24, 3, v107
v_add_u32 v107, 81920, v107
v_lshl_add_u32 v108, v23, 3, v106
v_lshlrev_b32 v108, 8, v108
v_lshl_add_u32 v108, v24, 3, v108
v_lshl_add_u32 v108, v23, 6, v108
v_and_b32 v24, 1, v106
v_lshl_add_u32 v108, v24, 5, v108
v_lshrrev_b32 v110, 4, v1
v_mul_u32_u24 v109, 7168, v110
v_and_b32 v111, 1, v110
v_lshrrev_b32 v110, 1, v110
v_lshl_add_u32 v110, v110, 3, v111
v_mul_u32_u24 v110, 3584, v110
v_and_b32 v23, 15, v1
v_lshl_add_u32 v109, v23, 4, v109
v_lshl_add_u32 v110, v23, 4, v110
v_mov_b32 v24, 0x7ff00000
s_cmp_eq_u32 s101, 3
s_cselect_b32 s28, 8, 16
v_lshrrev_b32 v109, 4, v1
v_and_b32 v25, 1, v109
v_lshlrev_b32 v25, 1, v25
v_xor_b32 v25, v25, v23
v_mul_u32_u24 v109, 896, v109
v_xor_b32 v28, 0, v25
v_lshl_add_u32 v236, v28, 4, v109
v_cmp_le_u32 vcc, s28, v28
s_nop 1
v_cndmask_b32 v236, v236, v24, vcc
v_xor_b32 v28, 4, v25
v_lshl_add_u32 v237, v28, 4, v109
v_cmp_le_u32 vcc, s28, v28
s_nop 1
v_cndmask_b32 v237, v237, v24, vcc
v_xor_b32 v28, 8, v25
v_lshl_add_u32 v238, v28, 4, v109
v_cmp_le_u32 vcc, s28, v28
s_nop 1
v_cndmask_b32 v238, v238, v24, vcc
v_xor_b32 v28, 12, v25
v_lshl_add_u32 v239, v28, 4, v109
v_cmp_le_u32 vcc, s28, v28
s_nop 1
v_cndmask_b32 v239, v239, v24, vcc
s_and_b32 s29, s2, 3
s_cmp_eq_u32 s29, 3
s_cselect_b32 s28, 8, 16
v_cmp_le_u32 vcc, s28, v23
s_nop 1
v_cndmask_b32 v110, v110, v24, vcc
s_mul_i32 s42, s56, 57344
s_lshl_b32 s28, s101, 8
s_add_u32 s42, s42, s28
s_lshr_b32 s43, s2, 2
s_mul_i32 s43, s43, 57344
s_lshl_b32 s28, s29, 8
s_add_u32 s43, s43, s28
s_cmp_lg_u32 s44, 0
s_cbranch_scc1 NI_58
v_mov_b32 v28, 48
v_mov_b32 v29, s16
v_mov_b32 v30, 0
s_add_u32 s28, s49, 319488
s_mov_b64 exec, 1
buffer_store_dwordx2 v[28:29], v30, s[12:15], s28 offen sc1
s_mov_b64 exec, -1
NI_58:
s_barrier
s_add_u32 m0, s47, 8192
s_nop 0
buffer_load_dwordx4 v224, s[4:7], s30 offen nt lds
s_waitcnt vmcnt(0)
s_add_u32 m0, s47, 9216
s_nop 0
buffer_load_dwordx4 v225, s[4:7], s30 offen nt lds
s_waitcnt vmcnt(0)
s_add_u32 m0, s47, 10240
s_nop 0
buffer_load_dwordx4 v226, s[4:7], s30 offen nt lds
s_waitcnt vmcnt(0)
s_add_u32 m0, s47, 11264
s_nop 0
buffer_load_dwordx4 v227, s[4:7], s30 offen nt lds
s_waitcnt vmcnt(3)
s_add_u32 m0, s47, 12288
s_nop 0
buffer_load_dwordx4 v228, s[4:7], s30 offen nt lds
s_waitcnt vmcnt(3)
s_add_u32 m0, s47, 13312
s_nop 0
buffer_load_dwordx4 v229, s[4:7], s30 offen nt lds
s_waitcnt vmcnt(3)
s_add_u32 m0, s47, 14336
s_nop 0
buffer_load_dwordx4 v230, s[4:7], s30 offen nt lds
s_waitcnt vmcnt(3)
s_add_u32 m0, s47, 15360
s_nop 0
buffer_load_dwordx4 v231, s[4:7], s30 offen nt lds
s_waitcnt vmcnt(3)
buffer_load_dwordx4 v[160:163], v93, s[8:11], s30 offen offset:0 nt
s_waitcnt vmcnt(3)
buffer_load_dwordx4 v[164:167], v93, s[8:11], s30 offen offset:256 nt
s_waitcnt vmcnt(3)
buffer_load_dwordx4 v[168:171], v93, s[8:11], s30 offen offset:2048 nt
s_waitcnt vmcnt(3)
buffer_load_dwordx4 v[172:175], v93, s[8:11], s30 offen offset:2304 nt
s_waitcnt lgkmcnt(0)
s_mov_b64 exec, 1
ds_add_u32 v2, v3 offset:52
s_mov_b64 exec, -1
s_waitcnt vmcnt(7)
buffer_load_dwordx4 v[176:179], v94, s[8:11], s30 offen offset:0 nt
s_waitcnt vmcnt(7)
buffer_load_dwordx4 v[180:183], v94, s[8:11], s30 offen offset:256 nt
s_waitcnt vmcnt(7)
buffer_load_dwordx4 v[184:187], v94, s[8:11], s30 offen offset:2048 nt
s_waitcnt vmcnt(7)
buffer_load_dwordx4 v[188:191], v94, s[8:11], s30 offen offset:2304 nt
s_add_u32 s44, s44, 24
s_mul_i32 s30, s44, 37
s_add_u32 s30, s30, s58
s_and_b32 s30, s30, 127
s_lshl_b32 s30, s30, 15
s_add_u32 s30, s30, s48
s_waitcnt vmcnt(7)
s_add_u32 m0, s47, 0
s_nop 0
buffer_load_dwordx4 v224, s[4:7], s30 offen nt lds
s_waitcnt vmcnt(7)
s_add_u32 m0, s47, 1024
s_nop 0
buffer_load_dwordx4 v225, s[4:7], s30 offen nt lds
s_waitcnt vmcnt(7)
s_add_u32 m0, s47, 2048
s_nop 0
buffer_load_dwordx4 v226, s[4:7], s30 offen nt lds
s_waitcnt vmcnt(7)
s_add_u32 m0, s47, 3072
s_nop 0
buffer_load_dwordx4 v227, s[4:7], s30 offen nt lds
s_waitcnt vmcnt(7)
s_add_u32 m0, s47, 4096
s_nop 0
buffer_load_dwordx4 v228, s[4:7], s30 offen nt lds
s_waitcnt vmcnt(7)
s_add_u32 m0, s47, 5120
s_nop 0
buffer_load_dwordx4 v229, s[4:7], s30 offen nt lds
s_waitcnt vmcnt(7)
s_add_u32 m0, s47, 6144
s_nop 0
buffer_load_dwordx4 v230, s[4:7], s30 offen nt lds
s_waitcnt vmcnt(7)
s_add_u32 m0, s47, 7168
s_nop 0
buffer_load_dwordx4 v231, s[4:7], s30 offen nt lds
s_waitcnt vmcnt(7)
buffer_load_dwordx4 v[128:131], v93, s[8:11], s30 offen offset:0 nt
s_waitcnt vmcnt(7)
buffer_load_dwordx4 v[132:135], v93, s[8:11], s30 offen offset:256 nt
s_waitcnt vmcnt(7)
buffer_load_dwordx4 v[136:139], v93, s[8:11], s30 offen offset:2048 nt
s_waitcnt vmcnt(7)
buffer_load_dwordx4 v[140:143], v93, s[8:11], s30 offen offset:2304 nt
s_waitcnt vmcnt(7)
buffer_load_dwordx4 v[144:147], v94, s[8:11], s30 offen offset:0 nt
s_waitcnt vmcnt(7)
buffer_load_dwordx4 v[148:151], v94, s[8:11], s30 offen offset:256 nt
s_waitcnt vmcnt(7)
buffer_load_dwordx4 v[152:155], v94, s[8:11], s30 offen offset:2048 nt
s_waitcnt vmcnt(7)
buffer_load_dwordx4 v[156:159], v94, s[8:11], s30 offen offset:2304 nt
S_pro:
v_bfe_u32 v23, v1, 3, 1
v_lshlrev_b32 v23, 9, v23
v_lshrrev_b32 v24, 4, v1
v_lshl_add_u32 v23, v24, 4, v23
v_add_u32 v23, 160768, v23
s_mov_b32 s33, 200000
LW_59:
ds_read_b32 v13, v2 offset:4
s_sub_u32 s33, s33, 1
s_cbranch_scc1 LE_60
s_waitcnt lgkmcnt(0)
v_readfirstlane_b32 s32, v13
s_nop 0
s_cmp_ge_u32 s32, 4
s_cbranch_scc1 LE_60
s_sleep 1
s_branch LW_59
LE_60:
s_waitcnt lgkmcnt(0)
ds_read_b128 v[32:35], v23 offset:0
ds_read_b128 v[36:39], v23 offset:64
ds_read_b128 v[40:43], v23 offset:128
ds_read_b128 v[44:47], v23 offset:192
ds_read_b128 v[48:51], v23 offset:256
ds_read_b128 v[52:55], v23 offset:320
ds_read_b128 v[56:59], v23 offset:384
ds_read_b128 v[60:63], v23 offset:448
s_waitcnt lgkmcnt(0)
s_waitcnt vmcnt(16)
ds_read_b128 v[192:195], v232 offset:8192
ds_read_b128 v[196:199], v233 offset:8192
ds_read_b128 v[200:203], v234 offset:8192
ds_read_b128 v[204:207], v235 offset:8192
ds_read_b128 v[208:211], v232 offset:8448
ds_read_b128 v[212:215], v233 offset:8448
ds_read_b128 v[216:219], v234 offset:8448
ds_read_b128 v[220:223], v235 offset:8448
s_waitcnt lgkmcnt(7)
v_mfma_f32_16x16x32_bf16 v[72:75], v[192:195], v[32:35], 0
s_waitcnt lgkmcnt(6)
v_mfma_f32_16x16x32_bf16 v[72:75], v[196:199], v[36:39], v[72:75]
s_waitcnt lgkmcnt(5)
v_mfma_f32_16x16x32_bf16 v[72:75], v[200:203], v[40:43], v[72:75]
s_waitcnt lgkmcnt(4)
v_mfma_f32_16x16x32_bf16 v[72:75], v[204:207], v[44:47], v[72:75]
s_waitcnt lgkmcnt(3)
v_mfma_f32_16x16x32_bf16 v[72:75], v[208:211], v[48:51], v[72:75]
s_waitcnt lgkmcnt(2)
v_mfma_f32_16x16x32_bf16 v[72:75], v[212:215], v[52:55], v[72:75]
s_waitcnt lgkmcnt(1)
v_mfma_f32_16x16x32_bf16 v[72:75], v[216:219], v[56:59], v[72:75]
s_waitcnt lgkmcnt(0)
v_mfma_f32_16x16x32_bf16 v[72:75], v[220:223], v[60:63], v[72:75]
s_nop 7
v_cvt_pk_bf16_f32 v28, v72, v73
v_cvt_pk_bf16_f32 v29, v74, v75
v_lshlrev_b32 v72, 16, v28
v_and_b32 v73, 0xffff0000, v28
v_lshlrev_b32 v74, 16, v29
v_and_b32 v75, 0xffff0000, v29
v_max3_f32 v28, v72, v73, v74
v_max_f32 v28, v28, v75
v_mov_b32 v29, v28
s_nop 1
v_permlane16_swap_b32 v28, v29
v_max_f32 v28, v28, v29
v_mov_b32 v29, v28
s_nop 1
v_permlane32_swap_b32 v28, v29
v_max_f32 v28, v28, v29
v_mul_f32 v28, s46, v28
v_max_f32 v28, v28, v26
v_sub_f32 v30, v26, v28
v_exp_f32 v30, v30
v_mov_b32 v26, v28
v_fma_f32 v72, v72, s46, -v26
v_fma_f32 v73, v73, s46, -v26
v_fma_f32 v74, v74, s46, -v26
v_fma_f32 v75, v75, s46, -v26
v_exp_f32 v72, v72
v_exp_f32 v73, v73
v_exp_f32 v74, v74
v_exp_f32 v75, v75
v_mul_f32 v64, v64, v30
v_mul_f32 v65, v65, v30
v_mul_f32 v66, v66, v30
v_mul_f32 v67, v67, v30
v_mul_f32 v68, v68, v30
v_mul_f32 v69, v69, v30
v_mul_f32 v70, v70, v30
v_mul_f32 v71, v71, v30
v_fma_f32 v27, v27, v30, v72
v_add_f32 v27, v27, v73
v_add_f32 v27, v27, v74
v_add_f32 v27, v27, v75
v_cvt_pk_bf16_f32 v28, v72, v73
v_cvt_pk_bf16_f32 v29, v74, v75
v_perm_b32 v76, v28, v28, v4
v_perm_b32 v77, v28, v28, v5
v_perm_b32 v78, v28, v28, v6
v_perm_b32 v79, v28, v28, v7
v_perm_b32 v80, v28, v28, v8
v_perm_b32 v81, v28, v28, v9
v_perm_b32 v82, v28, v28, v10
v_perm_b32 v83, v28, v28, v11
v_perm_b32 v84, v29, v29, v4
v_perm_b32 v85, v29, v29, v5
v_perm_b32 v86, v29, v29, v6
v_perm_b32 v87, v29, v29, v7
v_perm_b32 v88, v29, v29, v8
v_perm_b32 v89, v29, v29, v9
v_perm_b32 v90, v29, v29, v10
v_perm_b32 v91, v29, v29, v11
v_mfma_f32_16x16x32_bf16 v[64:67], v[160:163], v[76:79], v[64:67]
v_mfma_f32_16x16x32_bf16 v[68:71], v[164:167], v[76:79], v[68:71]
v_mfma_f32_16x16x32_bf16 v[64:67], v[168:171], v[80:83], v[64:67]
v_mfma_f32_16x16x32_bf16 v[68:71], v[172:175], v[80:83], v[68:71]
v_mfma_f32_16x16x32_bf16 v[64:67], v[176:179], v[84:87], v[64:67]
v_mfma_f32_16x16x32_bf16 v[68:71], v[180:183], v[84:87], v[68:71]
v_mfma_f32_16x16x32_bf16 v[64:67], v[184:187], v[88:91], v[64:67]
v_mfma_f32_16x16x32_bf16 v[68:71], v[188:191], v[88:91], v[68:71]
.p2align 6
S_loop:
s_mov_b64 s[50:51], 1
s_atomic_add_x2 s[50:51], s[12:13], s49 offset:319488 glc
s_waitcnt vmcnt(8)
ds_read_b128 v[192:195], v232 offset:0
ds_read_b128 v[196:199], v233 offset:0
ds_read_b128 v[200:203], v234 offset:0
ds_read_b128 v[204:207], v235 offset:0
ds_read_b128 v[208:211], v232 offset:256
ds_read_b128 v[212:215], v233 offset:256
ds_read_b128 v[216:219], v234 offset:256
ds_read_b128 v[220:223], v235 offset:256
s_waitcnt lgkmcnt(7)
v_mfma_f32_16x16x32_bf16 v[72:75], v[192:195], v[32:35], 0
s_waitcnt lgkmcnt(6)
v_mfma_f32_16x16x32_bf16 v[72:75], v[196:199], v[36:39], v[72:75]
s_waitcnt lgkmcnt(5)
v_mfma_f32_16x16x32_bf16 v[72:75], v[200:203], v[40:43], v[72:75]
s_waitcnt lgkmcnt(4)
v_mfma_f32_16x16x32_bf16 v[72:75], v[204:207], v[44:47], v[72:75]
s_waitcnt lgkmcnt(3)
v_mfma_f32_16x16x32_bf16 v[72:75], v[208:211], v[48:51], v[72:75]
s_waitcnt lgkmcnt(2)
v_mfma_f32_16x16x32_bf16 v[72:75], v[212:215], v[52:55], v[72:75]
s_waitcnt lgkmcnt(1)
v_mfma_f32_16x16x32_bf16 v[72:75], v[216:219], v[56:59], v[72:75]
s_waitcnt lgkmcnt(0)
v_mfma_f32_16x16x32_bf16 v[72:75], v[220:223], v[60:63], v[72:75]
s_nop 7
v_cvt_pk_bf16_f32 v28, v72, v73
v_cvt_pk_bf16_f32 v29, v74, v75
v_lshlrev_b32 v72, 16, v28
v_and_b32 v73, 0xffff0000, v28
v_lshlrev_b32 v74, 16, v29
v_and_b32 v75, 0xffff0000, v29
v_max3_f32 v28, v72, v73, v74
v_max_f32 v28, v28, v75
v_mov_b32 v29, v28
s_nop 1
v_permlane16_swap_b32 v28, v29
v_max_f32 v28, v28, v29
v_mov_b32 v29, v28
s_nop 1
v_permlane32_swap_b32 v28, v29
v_max_f32 v28, v28, v29
v_mul_f32 v28, s46, v28
v_max_f32 v28, v28, v26
v_sub_f32 v30, v26, v28
v_exp_f32 v30, v30
v_mov_b32 v26, v28
v_fma_f32 v72, v72, s46, -v26
v_fma_f32 v73, v73, s46, -v26
v_fma_f32 v74, v74, s46, -v26
v_fma_f32 v75, v75, s46, -v26
v_exp_f32 v72, v72
v_exp_f32 v73, v73
v_exp_f32 v74, v74
v_exp_f32 v75, v75
v_mul_f32 v64, v64, v30
v_mul_f32 v65, v65, v30
v_mul_f32 v66, v66, v30
v_mul_f32 v67, v67, v30
v_mul_f32 v68, v68, v30
v_mul_f32 v69, v69, v30
v_mul_f32 v70, v70, v30
v_mul_f32 v71, v71, v30
v_fma_f32 v27, v27, v30, v72
v_add_f32 v27, v27, v73
v_add_f32 v27, v27, v74
v_add_f32 v27, v27, v75
v_cvt_pk_bf16_f32 v28, v72, v73
v_cvt_pk_bf16_f32 v29, v74, v75
v_perm_b32 v76, v28, v28, v4
v_perm_b32 v77, v28, v28, v5
v_perm_b32 v78, v28, v28, v6
v_perm_b32 v79, v28, v28, v7
v_perm_b32 v80, v28, v28, v8
v_perm_b32 v81, v28, v28, v9
v_perm_b32 v82, v28, v28, v10
v_perm_b32 v83, v28, v28, v11
v_perm_b32 v84, v29, v29, v4
v_perm_b32 v85, v29, v29, v5
v_perm_b32 v86, v29, v29, v6
v_perm_b32 v87, v29, v29, v7
v_perm_b32 v88, v29, v29, v8
v_perm_b32 v89, v29, v29, v9
v_perm_b32 v90, v29, v29, v10
v_perm_b32 v91, v29, v29, v11
s_mov_b32 s33, 25000
CK_61:
s_waitcnt lgkmcnt(0)
s_cmp_eq_u32 s51, s16
s_cbranch_scc1 CO_62
s_sub_u32 s33, s33, 1
s_cbranch_scc1 S_exit
s_mov_b64 s[50:51], 1
s_atomic_add_x2 s[50:51], s[12:13], s49 offset:319488 glc
s_branch CK_61
CO_62:
s_cmp_ge_u32 s50, 168
s_cbranch_scc1 S_exit
s_sub_u32 s28, s50, 88
s_cselect_b32 s28, 0, s28
s_add_u32 s29, s28, 1
s_lshr_b32 s29, s29, 1
s_sub_u32 s29, s50, s29
s_mul_i32 s30, s29, 37
s_add_u32 s30, s30, s58
s_and_b32 s30, s30, 127
s_lshl_b32 s30, s30, 15
s_add_u32 s30, s30, s48
s_and_b32 s28, s28, 1
s_lshl_b32 s28, s28, 12
s_add_u32 s30, s30, s28
s_cmp_ge_u32 s50, 88
s_cbranch_scc1 S_drain
s_waitcnt vmcnt(11)
s_add_u32 m0, s47, 0
s_nop 0
buffer_load_dwordx4 v224, s[4:7], s30 offen nt lds
s_waitcnt vmcnt(11)
s_add_u32 m0, s47, 1024
s_nop 0
buffer_load_dwordx4 v225, s[4:7], s30 offen nt lds
s_waitcnt vmcnt(11)
s_add_u32 m0, s47, 2048
s_nop 0
buffer_load_dwordx4 v226, s[4:7], s30 offen nt lds
s_waitcnt vmcnt(11)
s_add_u32 m0, s47, 3072
s_nop 0
buffer_load_dwordx4 v227, s[4:7], s30 offen nt lds
s_waitcnt vmcnt(11)
s_add_u32 m0, s47, 4096
s_nop 0
buffer_load_dwordx4 v228, s[4:7], s30 offen nt lds
v_mfma_f32_16x16x32_bf16 v[64:67], v[128:131], v[76:79], v[64:67]
s_waitcnt vmcnt(11)
s_add_u32 m0, s47, 5120
s_nop 0
buffer_load_dwordx4 v229, s[4:7], s30 offen nt lds
v_mfma_f32_16x16x32_bf16 v[68:71], v[132:135], v[76:79], v[68:71]
s_waitcnt vmcnt(11)
s_add_u32 m0, s47, 6144
s_nop 0
buffer_load_dwordx4 v230, s[4:7], s30 offen nt lds
v_mfma_f32_16x16x32_bf16 v[64:67], v[136:139], v[80:83], v[64:67]
s_waitcnt vmcnt(11)
s_add_u32 m0, s47, 7168
s_nop 0
buffer_load_dwordx4 v231, s[4:7], s30 offen nt lds
v_mfma_f32_16x16x32_bf16 v[68:71], v[140:143], v[80:83], v[68:71]
s_waitcnt vmcnt(11)
v_mfma_f32_16x16x32_bf16 v[64:67], v[144:147], v[84:87], v[64:67]
buffer_load_dwordx4 v[128:131], v93, s[8:11], s30 offen offset:0 nt
s_waitcnt vmcnt(11)
v_mfma_f32_16x16x32_bf16 v[68:71], v[148:151], v[84:87], v[68:71]
buffer_load_dwordx4 v[132:135], v93, s[8:11], s30 offen offset:256 nt
s_waitcnt vmcnt(11)
v_mfma_f32_16x16x32_bf16 v[64:67], v[152:155], v[88:91], v[64:67]
buffer_load_dwordx4 v[136:139], v93, s[8:11], s30 offen offset:2048 nt
s_waitcnt vmcnt(11)
v_mfma_f32_16x16x32_bf16 v[68:71], v[156:159], v[88:91], v[68:71]
buffer_load_dwordx4 v[140:143], v93, s[8:11], s30 offen offset:2304 nt
s_waitcnt vmcnt(11)
buffer_load_dwordx4 v[144:147], v94, s[8:11], s30 offen offset:0 nt
s_waitcnt vmcnt(11)
buffer_load_dwordx4 v[148:151], v94, s[8:11], s30 offen offset:256 nt
s_waitcnt vmcnt(11)
buffer_load_dwordx4 v[152:155], v94, s[8:11], s30 offen offset:2048 nt
s_waitcnt vmcnt(11)
buffer_load_dwordx4 v[156:159], v94, s[8:11], s30 offen offset:2304 nt
s_branch S_loop
S_drain:
s_waitcnt vmcnt(7)
v_mfma_f32_16x16x32_bf16 v[64:67], v[128:131], v[76:79], v[64:67]
s_waitcnt vmcnt(6)
v_mfma_f32_16x16x32_bf16 v[68:71], v[132:135], v[76:79], v[68:71]
s_waitcnt vmcnt(5)
v_mfma_f32_16x16x32_bf16 v[64:67], v[136:139], v[80:83], v[64:67]
s_waitcnt vmcnt(4)
v_mfma_f32_16x16x32_bf16 v[68:71], v[140:143], v[80:83], v[68:71]
s_waitcnt vmcnt(3)
v_mfma_f32_16x16x32_bf16 v[64:67], v[144:147], v[84:87], v[64:67]
s_waitcnt vmcnt(2)
v_mfma_f32_16x16x32_bf16 v[68:71], v[148:151], v[84:87], v[68:71]
s_waitcnt vmcnt(1)
v_mfma_f32_16x16x32_bf16 v[64:67], v[152:155], v[88:91], v[64:67]
s_waitcnt vmcnt(0)
v_mfma_f32_16x16x32_bf16 v[68:71], v[156:159], v[88:91], v[68:71]
S_issue:
s_cmp_ge_u32 s50, 88
s_cbranch_scc1 S_hfirst
s_add_u32 m0, s47, 0
s_nop 0
buffer_load_dwordx4 v224, s[4:7], s30 offen nt lds
s_add_u32 m0, s47, 1024
s_nop 0
buffer_load_dwordx4 v225, s[4:7], s30 offen nt lds
s_add_u32 m0, s47, 2048
s_nop 0
buffer_load_dwordx4 v226, s[4:7], s30 offen nt lds
s_add_u32 m0, s47, 3072
s_nop 0
buffer_load_dwordx4 v227, s[4:7], s30 offen nt lds
s_add_u32 m0, s47, 4096
s_nop 0
buffer_load_dwordx4 v228, s[4:7], s30 offen nt lds
s_add_u32 m0, s47, 5120
s_nop 0
buffer_load_dwordx4 v229, s[4:7], s30 offen nt lds
s_add_u32 m0, s47, 6144
s_nop 0
buffer_load_dwordx4 v230, s[4:7], s30 offen nt lds
s_add_u32 m0, s47, 7168
s_nop 0
buffer_load_dwordx4 v231, s[4:7], s30 offen nt lds
buffer_load_dwordx4 v[128:131], v93, s[8:11], s30 offen offset:0 nt
buffer_load_dwordx4 v[132:135], v93, s[8:11], s30 offen offset:256 nt
buffer_load_dwordx4 v[136:139], v93, s[8:11], s30 offen offset:2048 nt
buffer_load_dwordx4 v[140:143], v93, s[8:11], s30 offen offset:2304 nt
buffer_load_dwordx4 v[144:147], v94, s[8:11], s30 offen offset:0 nt
buffer_load_dwordx4 v[148:151], v94, s[8:11], s30 offen offset:256 nt
buffer_load_dwordx4 v[152:155], v94, s[8:11], s30 offen offset:2048 nt
buffer_load_dwordx4 v[156:159], v94, s[8:11], s30 offen offset:2304 nt
s_branch S_loop
S_hfirst:
s_getpc_b64 s[64:65]
S_pcref:
s_mov_b32 s66, L_codeend - S_pcref
s_mov_b32 s67, 0x00020000
v_lshlrev_b32 v14, 7, v1
buffer_load_dword v255, v14, s[64:67], 0 offen
S_hissue:
s_add_u32 m0, s47, 0
s_nop 0
buffer_load_dwordx4 v224, s[4:7], s30 offen nt lds
s_add_u32 m0, s47, 1024
s_nop 0
buffer_load_dwordx4 v225, s[4:7], s30 offen nt lds
s_add_u32 m0, s47, 2048
s_nop 0
buffer_load_dwordx4 v226, s[4:7], s30 offen nt lds
s_add_u32 m0, s47, 3072
s_nop 0
buffer_load_dwordx4 v227, s[4:7], s30 offen nt lds
buffer_load_dwordx4 v[128:131], v93, s[8:11], s30 offen offset:0 nt
buffer_load_dwordx4 v[132:135], v93, s[8:11], s30 offen offset:256 nt
buffer_load_dwordx4 v[136:139], v93, s[8:11], s30 offen offset:2048 nt
buffer_load_dwordx4 v[140:143], v93, s[8:11], s30 offen offset:2304 nt
s_mov_b64 s[50:51], 1
s_atomic_add_x2 s[50:51], s[12:13], s49 offset:319488 glc
s_waitcnt vmcnt(4)
ds_read_b128 v[192:195], v232 offset:0
ds_read_b128 v[196:199], v233 offset:0
ds_read_b128 v[200:203], v234 offset:0
ds_read_b128 v[204:207], v235 offset:0
ds_read_b128 v[208:211], v232 offset:256
ds_read_b128 v[212:215], v233 offset:256
ds_read_b128 v[216:219], v234 offset:256
ds_read_b128 v[220:223], v235 offset:256
s_waitcnt lgkmcnt(7)
v_mfma_f32_16x16x32_bf16 v[72:75], v[192:195], v[32:35], 0
s_waitcnt lgkmcnt(6)
v_mfma_f32_16x16x32_bf16 v[72:75], v[196:199], v[36:39], v[72:75]
s_waitcnt lgkmcnt(5)
v_mfma_f32_16x16x32_bf16 v[72:75], v[200:203], v[40:43], v[72:75]
s_waitcnt lgkmcnt(4)
v_mfma_f32_16x16x32_bf16 v[72:75], v[204:207], v[44:47], v[72:75]
s_waitcnt lgkmcnt(3)
v_mfma_f32_16x16x32_bf16 v[72:75], v[208:211], v[48:51], v[72:75]
s_waitcnt lgkmcnt(2)
v_mfma_f32_16x16x32_bf16 v[72:75], v[212:215], v[52:55], v[72:75]
s_waitcnt lgkmcnt(1)
v_mfma_f32_16x16x32_bf16 v[72:75], v[216:219], v[56:59], v[72:75]
s_waitcnt lgkmcnt(0)
v_mfma_f32_16x16x32_bf16 v[72:75], v[220:223], v[60:63], v[72:75]
s_nop 7
v_cvt_pk_bf16_f32 v28, v72, v73
v_lshlrev_b32 v72, 16, v28
v_and_b32 v73, 0xffff0000, v28
v_max_f32 v28, v72, v73
v_mov_b32 v29, v28
s_nop 1
v_permlane16_swap_b32 v28, v29
v_max_f32 v28, v28, v29
v_mov_b32 v29, v28
s_nop 1
v_permlane32_swap_b32 v28, v29
v_max_f32 v28, v28, v29
v_mul_f32 v28, s46, v28
v_max_f32 v28, v28, v26
v_sub_f32 v30, v26, v28
v_exp_f32 v30, v30
v_mov_b32 v26, v28
v_fma_f32 v72, v72, s46, -v26
v_fma_f32 v73, v73, s46, -v26
v_exp_f32 v72, v72
v_exp_f32 v73, v73
v_mul_f32 v64, v64, v30
v_mul_f32 v65, v65, v30
v_mul_f32 v66, v66, v30
v_mul_f32 v67, v67, v30
v_mul_f32 v68, v68, v30
v_mul_f32 v69, v69, v30
v_mul_f32 v70, v70, v30
v_mul_f32 v71, v71, v30
v_fma_f32 v27, v27, v30, v72
v_add_f32 v27, v27, v73
v_cvt_pk_bf16_f32 v28, v72, v73
v_perm_b32 v76, v28, v28, v4
v_perm_b32 v77, v28, v28, v5
v_perm_b32 v78, v28, v28, v6
v_perm_b32 v79, v28, v28, v7
v_perm_b32 v80, v28, v28, v8
v_perm_b32 v81, v28, v28, v9
v_perm_b32 v82, v28, v28, v10
v_perm_b32 v83, v28, v28, v11
s_mov_b32 s33, 25000
CK_63:
s_waitcnt lgkmcnt(0)
s_cmp_eq_u32 s51, s16
s_cbranch_scc1 CO_64
s_sub_u32 s33, s33, 1
s_cbranch_scc1 S_hexit
s_mov_b64 s[50:51], 1
s_atomic_add_x2 s[50:51], s[12:13], s49 offset:319488 glc
s_branch CK_63
CO_64:
s_cmp_ge_u32 s50, 168
s_cbranch_scc1 S_hexit
s_sub_u32 s28, s50, 88
s_cselect_b32 s28, 0, s28
s_add_u32 s29, s28, 1
s_lshr_b32 s29, s29, 1
s_sub_u32 s29, s50, s29
s_mul_i32 s30, s29, 37
s_add_u32 s30, s30, s58
s_and_b32 s30, s30, 127
s_lshl_b32 s30, s30, 15
s_add_u32 s30, s30, s48
s_and_b32 s28, s28, 1
s_lshl_b32 s28, s28, 12
s_add_u32 s30, s30, s28
s_waitcnt vmcnt(3)
v_mfma_f32_16x16x32_bf16 v[64:67], v[128:131], v[76:79], v[64:67]
s_waitcnt vmcnt(2)
v_mfma_f32_16x16x32_bf16 v[68:71], v[132:135], v[76:79], v[68:71]
s_waitcnt vmcnt(1)
v_mfma_f32_16x16x32_bf16 v[64:67], v[136:139], v[80:83], v[64:67]
s_waitcnt vmcnt(0)
v_mfma_f32_16x16x32_bf16 v[68:71], v[140:143], v[80:83], v[68:71]
s_branch S_hissue
S_next:
s_mov_b32 s33, 25000
CK_65:
s_waitcnt lgkmcnt(0)
s_cmp_eq_u32 s51, s16
s_cbranch_scc1 CO_66
s_sub_u32 s33, s33, 1
s_cbranch_scc1 S_exit0
s_mov_b64 s[50:51], 1
s_atomic_add_x2 s[50:51], s[12:13], s49 offset:319488 glc
s_branch CK_65
CO_66:
s_cmp_ge_u32 s50, 168
s_cbranch_scc1 S_exit0
s_sub_u32 s28, s50, 88
s_cselect_b32 s28, 0, s28
s_add_u32 s29, s28, 1
s_lshr_b32 s29, s29, 1
s_sub_u32 s29, s50, s29
s_mul_i32 s30, s29, 37
s_add_u32 s30, s30, s58
s_and_b32 s30, s30, 127
s_lshl_b32 s30, s30, 15
s_add_u32 s30, s30, s48
s_and_b32 s28, s28, 1
s_lshl_b32 s28, s28, 12
s_add_u32 s30, s30, s28
s_branch S_issue
S_exit:
v_mov_b32 v24, v27
s_nop 1
v_permlane16_swap_b32 v27, v24
v_add_f32 v27, v27, v24
v_mov_b32 v24, v27
s_nop 1
v_permlane32_swap_b32 v27, v24
v_add_f32 v27, v27, v24
s_mov_b64 exec, 0xffff
ds_write_b64 v241, v[26:27]
v_mov_b32 v24, s50
s_mov_b64 exec, 1
ds_max_u32 v2, v24 offset:36
ds_add_u32 v2, v3 offset:32
s_mov_b64 exec, -1
s_waitcnt vmcnt(7)
v_mfma_f32_16x16x32_bf16 v[64:67], v[128:131], v[76:79], v[64:67]
s_waitcnt vmcnt(6)
v_mfma_f32_16x16x32_bf16 v[68:71], v[132:135], v[76:79], v[68:71]
s_waitcnt vmcnt(5)
v_mfma_f32_16x16x32_bf16 v[64:67], v[136:139], v[80:83], v[64:67]
s_waitcnt vmcnt(4)
v_mfma_f32_16x16x32_bf16 v[68:71], v[140:143], v[80:83], v[68:71]
s_waitcnt vmcnt(3)
v_mfma_f32_16x16x32_bf16 v[64:67], v[144:147], v[84:87], v[64:67]
s_waitcnt vmcnt(2)
v_mfma_f32_16x16x32_bf16 v[68:71], v[148:151], v[84:87], v[68:71]
s_waitcnt vmcnt(1)
v_mfma_f32_16x16x32_bf16 v[64:67], v[152:155], v[88:91], v[64:67]
s_waitcnt vmcnt(0)
v_mfma_f32_16x16x32_bf16 v[68:71], v[156:159], v[88:91], v[68:71]
s_branch S_fin
S_hexit:
v_mov_b32 v24, v27
s_nop 1
v_permlane16_swap_b32 v27, v24
v_add_f32 v27, v27, v24
v_mov_b32 v24, v27
s_nop 1
v_permlane32_swap_b32 v27, v24
v_add_f32 v27, v27, v24
s_mov_b64 exec, 0xffff
ds_write_b64 v241, v[26:27]
v_mov_b32 v24, s50
s_mov_b64 exec, 1
ds_max_u32 v2, v24 offset:36
ds_add_u32 v2, v3 offset:32
s_mov_b64 exec, -1
s_waitcnt vmcnt(3)
v_mfma_f32_16x16x32_bf16 v[64:67], v[128:131], v[76:79], v[64:67]
s_waitcnt vmcnt(2)
v_mfma_f32_16x16x32_bf16 v[68:71], v[132:135], v[76:79], v[68:71]
s_waitcnt vmcnt(1)
v_mfma_f32_16x16x32_bf16 v[64:67], v[136:139], v[80:83], v[64:67]
s_waitcnt vmcnt(0)
v_mfma_f32_16x16x32_bf16 v[68:71], v[140:143], v[80:83], v[68:71]
s_branch S_fin
S_exit0:
v_mov_b32 v24, v27
s_nop 1
v_permlane16_swap_b32 v27, v24
v_add_f32 v27, v27, v24
v_mov_b32 v24, v27
s_nop 1
v_permlane32_swap_b32 v27, v24
v_add_f32 v27, v27, v24
s_mov_b64 exec, 0xffff
ds_write_b64 v241, v[26:27]
v_mov_b32 v24, s50
s_mov_b64 exec, 1
ds_max_u32 v2, v24 offset:36
ds_add_u32 v2, v3 offset:32
s_mov_b64 exec, -1
S_fin:
s_nop 6
ds_write_b128 v240, v[64:67]
ds_write_b128 v240, v[68:71] offset:1024
s_mov_b64 exec, 1
ds_add_rtn_u32 v13, v2, v3 offset:48
s_mov_b64 exec, -1
ds_read_b64 v[64:65], v102 offset:0
ds_read_b64 v[66:67], v102 offset:128
ds_read_b64 v[68:69], v102 offset:256
ds_read_b64 v[70:71], v102 offset:384
ds_read_b128 v[32:35], v101 offset:0
ds_read_b128 v[36:39], v101 offset:1024
ds_read_b128 v[40:43], v101 offset:2048
ds_read_b128 v[44:47], v101 offset:3072
ds_read_b128 v[48:51], v101 offset:4096
ds_read_b128 v[52:55], v101 offset:5120
ds_read_b128 v[56:59], v101 offset:6144
ds_read_b128 v[60:63], v101 offset:7168
s_waitcnt lgkmcnt(12)
v_readfirstlane_b32 s28, v13
s_nop 0
s_cmp_lg_u32 s28, 3
s_cbranch_scc1 S_help
s_setprio 3
s_waitcnt lgkmcnt(8)
v_max3_f32 v72, v64, v66, v68
v_max_f32 v72, v72, v70
v_sub_f32 v64, v64, v72
v_sub_f32 v66, v66, v72
v_sub_f32 v68, v68, v72
v_sub_f32 v70, v70, v72
v_exp_f32 v64, v64
v_exp_f32 v66, v66
v_exp_f32 v68, v68
v_exp_f32 v70, v70
v_mul_f32 v73, v64, v65
v_fmac_f32 v73, v66, v67
v_fmac_f32 v73, v68, v69
v_fmac_f32 v73, v70, v71
v_max_f32 v73, 0x0d800000, v73
v_rcp_f32 v73, v73
s_nop 0
v_mul_f32 v64, v64, v73
v_mul_f32 v66, v66, v73
v_mul_f32 v68, v68, v73
v_mul_f32 v70, v70, v73
s_waitcnt lgkmcnt(0)
v_mul_f32 v32, v64, v32
v_mul_f32 v33, v64, v33
v_mul_f32 v34, v64, v34
v_mul_f32 v35, v64, v35
v_fmac_f32 v32, v66, v40
v_fmac_f32 v33, v66, v41
v_fmac_f32 v34, v66, v42
v_fmac_f32 v35, v66, v43
v_fmac_f32 v32, v68, v48
v_fmac_f32 v33, v68, v49
v_fmac_f32 v34, v68, v50
v_fmac_f32 v35, v68, v51
v_fmac_f32 v32, v70, v56
v_fmac_f32 v33, v70, v57
v_fmac_f32 v34, v70, v58
v_fmac_f32 v35, v70, v59
v_perm_b32 v76, v33, v32, v16
v_add_u32 v76, 0x00010001, v76
v_and_or_b32 v76, v76, v17, v242
v_perm_b32 v77, v35, v34, v16
v_add_u32 v77, 0x00010001, v77
v_and_or_b32 v77, v77, v17, v243
buffer_store_dwordx2 v[76:77], v103, s[12:15], s38 offen sc1
v_mul_f32 v36, v64, v36
v_mul_f32 v37, v64, v37
v_mul_f32 v38, v64, v38
v_mul_f32 v39, v64, v39
v_fmac_f32 v36, v66, v44
v_fmac_f32 v37, v66, v45
v_fmac_f32 v38, v66, v46
v_fmac_f32 v39, v66, v47
v_fmac_f32 v36, v68, v52
v_fmac_f32 v37, v68, v53
v_fmac_f32 v38, v68, v54
v_fmac_f32 v39, v68, v55
v_fmac_f32 v36, v70, v60
v_fmac_f32 v37, v70, v61
v_fmac_f32 v38, v70, v62
v_fmac_f32 v39, v70, v63
v_perm_b32 v78, v37, v36, v16
v_add_u32 v78, 0x00010001, v78
v_and_or_b32 v78, v78, v17, v242
v_perm_b32 v79, v39, v38, v16
v_add_u32 v79, 0x00010001, v79
v_and_or_b32 v79, v79, v17, v243
buffer_store_dwordx2 v[78:79], v104, s[12:15], s38 offen sc1
s_endpgm
S_help:
s_cmp_eq_u32 s28, 0
s_cbranch_scc1 S_cons
s_cmp_lg_u32 s28, 1
s_cbranch_scc1 L_end
s_mov_b32 s64, s70
s_mov_b32 s65, s71
s_mov_b32 s66, 3670016
s_mov_b32 s67, 0x00020000
s_mov_b32 s33, 200000
LW_67:
ds_read_b32 v13, v2 offset:32
s_sub_u32 s33, s33, 1
s_cbranch_scc1 LE_68
s_waitcnt lgkmcnt(0)
v_readfirstlane_b32 s32, v13
s_nop 0
s_cmp_ge_u32 s32, 3
s_cbranch_scc0 LW_67
LE_68:
s_waitcnt lgkmcnt(0)
s_mov_b32 m0, 114688
s_add_u32 s28, s43, 0
buffer_load_dwordx4 v110, s[64:67], s28 offen nt lds
s_mov_b32 m0, 115712
s_add_u32 s28, s43, 7168
buffer_load_dwordx4 v110, s[64:67], s28 offen nt lds
s_mov_b32 m0, 116736
s_add_u32 s28, s43, 14336
buffer_load_dwordx4 v110, s[64:67], s28 offen nt lds
s_mov_b32 m0, 117760
s_add_u32 s28, s43, 21504
buffer_load_dwordx4 v110, s[64:67], s28 offen nt lds
s_mov_b32 m0, 118784
s_add_u32 s28, s43, 896
buffer_load_dwordx4 v110, s[64:67], s28 offen nt lds
s_mov_b32 m0, 119808
s_add_u32 s28, s43, 8064
buffer_load_dwordx4 v110, s[64:67], s28 offen nt lds
s_mov_b32 m0, 120832
s_add_u32 s28, s43, 15232
buffer_load_dwordx4 v110, s[64:67], s28 offen nt lds
s_mov_b32 m0, 121856
s_add_u32 s28, s43, 22400
buffer_load_dwordx4 v110, s[64:67], s28 offen nt lds
s_mov_b32 s33, 200000
LW_69:
ds_read_b32 v13, v2 offset:32
s_sub_u32 s33, s33, 1
s_cbranch_scc1 LE_70
s_waitcnt lgkmcnt(0)
v_readfirstlane_b32 s32, v13
s_nop 0
s_cmp_ge_u32 s32, 4
s_cbranch_scc0 LW_69
LE_70:
s_waitcnt lgkmcnt(0)
ds_read_b64 v[64:65], v102 offset:0
ds_read_b64 v[66:67], v102 offset:128
ds_read_b64 v[68:69], v102 offset:256
ds_read_b64 v[70:71], v102 offset:384
ds_read_b32 v13, v2 offset:36
s_waitcnt lgkmcnt(0)
v_readfirstlane_b32 s55, v13
v_max3_f32 v72, v64, v66, v68
v_max_f32 v72, v72, v70
v_sub_f32 v64, v64, v72
v_sub_f32 v66, v66, v72
v_sub_f32 v68, v68, v72
v_sub_f32 v70, v70, v72
v_exp_f32 v64, v64
v_exp_f32 v66, v66
v_exp_f32 v68, v68
v_exp_f32 v70, v70
v_mul_f32 v73, v64, v65
v_fmac_f32 v73, v66, v67
v_fmac_f32 v73, v68, v69
v_fmac_f32 v73, v70, v71
v_max_f32 v73, 0x0d800000, v73
v_log_f32 v73, v73
s_nop 0
v_add_f32 v72, v72, v73
v_mov_b32 v73, s16
s_mov_b32 exec_lo, 0x1010101
s_mov_b32 exec_hi, 0x1010101
buffer_store_dwordx2 v[72:73], v105, s[12:15], s39 offen sc1
s_mov_b64 exec, -1
s_cmp_ge_u32 s55, 267
s_cbranch_scc1 LB_71
s_waitcnt vmcnt(7)
s_mov_b32 m0, 122880
s_add_u32 s28, s43, 1792
buffer_load_dwordx4 v110, s[64:67], s28 offen nt lds
s_waitcnt vmcnt(7)
s_mov_b32 m0, 123904
s_add_u32 s28, s43, 8960
buffer_load_dwordx4 v110, s[64:67], s28 offen nt lds
s_waitcnt vmcnt(7)
s_mov_b32 m0, 124928
s_add_u32 s28, s43, 16128
buffer_load_dwordx4 v110, s[64:67], s28 offen nt lds
s_waitcnt vmcnt(7)
s_mov_b32 m0, 125952
s_add_u32 s28, s43, 23296
buffer_load_dwordx4 v110, s[64:67], s28 offen nt lds
s_waitcnt vmcnt(7)
s_mov_b32 m0, 126976
s_add_u32 s28, s43, 2688
buffer_load_dwordx4 v110, s[64:67], s28 offen nt lds
s_waitcnt vmcnt(7)
s_mov_b32 m0, 128000
s_add_u32 s28, s43, 9856
buffer_load_dwordx4 v110, s[64:67], s28 offen nt lds
s_waitcnt vmcnt(7)
s_mov_b32 m0, 129024
s_add_u32 s28, s43, 17024
buffer_load_dwordx4 v110, s[64:67], s28 offen nt lds
s_waitcnt vmcnt(7)
s_mov_b32 m0, 130048
s_add_u32 s28, s43, 24192
buffer_load_dwordx4 v110, s[64:67], s28 offen nt lds
s_branch LJ_72
LB_71:
s_mov_b32 m0, 122880
s_add_u32 s28, s43, 1792
buffer_load_dwordx4 v110, s[64:67], s28 offen nt lds
s_mov_b32 m0, 123904
s_add_u32 s28, s43, 8960
buffer_load_dwordx4 v110, s[64:67], s28 offen nt lds
s_mov_b32 m0, 124928
s_add_u32 s28, s43, 16128
buffer_load_dwordx4 v110, s[64:67], s28 offen nt lds
s_mov_b32 m0, 125952
s_add_u32 s28, s43, 23296
buffer_load_dwordx4 v110, s[64:67], s28 offen nt lds
s_mov_b32 m0, 126976
s_add_u32 s28, s43, 2688
buffer_load_dwordx4 v110, s[64:67], s28 offen nt lds
s_mov_b32 m0, 128000
s_add_u32 s28, s43, 9856
buffer_load_dwordx4 v110, s[64:67], s28 offen nt lds
s_mov_b32 m0, 129024
s_add_u32 s28, s43, 17024
buffer_load_dwordx4 v110, s[64:67], s28 offen nt lds
s_mov_b32 m0, 130048
s_add_u32 s28, s43, 24192
buffer_load_dwordx4 v110, s[64:67], s28 offen nt lds
LJ_72:
s_mov_b32 s54, 163112
s_waitcnt vmcnt(0)
v_mov_b32 v13, s54
s_mov_b64 exec, 1
ds_add_u32 v13, v3
s_mov_b64 exec, -1
s_endpgm
S_cons:
s_setprio 3
s_mov_b32 s8, s24
s_mov_b32 s9, s25
s_mov_b32 s10, 3670016
s_mov_b32 s11, 0x00020000
s_mov_b32 s100, s42
v_and_b32 v154, 15, v1
v_lshrrev_b32 v154, v154, s16
v_bfe_u32 v152, v154, 0, 1
v_bfe_u32 v153, v154, 16, 1
v_lshl_or_b32 v152, v152, 16, v152
v_lshl_or_b32 v153, v153, 16, v153
s_mov_b32 s20, s40
s_mov_b32 s21, s60
s_lshl_b32 s23, s56, 11
s_lshl_b32 s29, s101, 9
s_add_u32 s23, s23, s29
s_add_u32 s23, s23, 720896
s_cmp_eq_u32 s101, 3
s_cselect_b32 s24, 0xffff, -1
s_and_b32 s7, s2, 7
s_lshl_b32 s7, s7, 3
s_and_b32 s28, s2, 64
s_add_u32 s7, s7, s28
s_bfe_u32 s28, s2, 0x30003
s_add_u32 s7, s7, s28
s_cmp_ge_u32 s2, 128
s_cselect_b32 s7, 0x7f, s7
v_lshlrev_b32 v28, 11, v1
s_lshl_b32 s4, s7, 4
s_add_u32 s4, s4, 720896
v_lshrrev_b32 v29, 4, v1
v_lshlrev_b32 v30, 1, v29
v_and_b32 v30, 2, v30
v_lshrrev_b32 v29, 1, v29
v_or_b32 v29, v29, v30
v_lshlrev_b32 v29, 5, v29
s_lshr_b32 s5, s7, 4
s_lshl_b32 s5, s5, 6
s_and_b32 s29, s7, 15
s_add_u32 s5, s5, s29
s_lshl_b32 s5, s5, 1
s_and_b32 s6, s7, 7
s_lshl_b32 s6, s6, 10
s_lshr_b32 s28, s7, 5
s_lshl_b32 s28, s28, 8
s_add_u32 s6, s6, s28
s_mov_b32 s25, 25000
s_mov_b32 s35, 0
s_mov_b32 s33, 200000
LW_73:
ds_read_b32 v13, v2 offset:32
s_sub_u32 s33, s33, 1
s_cbranch_scc1 LE_74
s_waitcnt lgkmcnt(0)
v_readfirstlane_b32 s32, v13
s_nop 0
s_cmp_ge_u32 s32, 4
s_cbranch_scc0 LW_73
LE_74:
s_waitcnt lgkmcnt(0)
s_mov_b32 m0, 0
s_add_u32 s28, s100, 0
buffer_load_dwordx4 v236, s[8:11], s28 offen nt lds
s_mov_b32 m0, 1024
s_add_u32 s28, s100, 3584
buffer_load_dwordx4 v236, s[8:11], s28 offen nt lds
s_mov_b32 m0, 2048
s_add_u32 s28, s100, 7168
buffer_load_dwordx4 v237, s[8:11], s28 offen nt lds
s_mov_b32 m0, 3072
s_add_u32 s28, s100, 10752
buffer_load_dwordx4 v237, s[8:11], s28 offen nt lds
s_mov_b32 m0, 4096
s_add_u32 s28, s100, 14336
buffer_load_dwordx4 v238, s[8:11], s28 offen nt lds
s_mov_b32 m0, 5120
s_add_u32 s28, s100, 17920
buffer_load_dwordx4 v238, s[8:11], s28 offen nt lds
s_mov_b32 m0, 6144
s_add_u32 s28, s100, 21504
buffer_load_dwordx4 v239, s[8:11], s28 offen nt lds
s_mov_b32 m0, 7168
s_add_u32 s28, s100, 25088
buffer_load_dwordx4 v239, s[8:11], s28 offen nt lds
ds_read_b32 v13, v2 offset:36
s_waitcnt lgkmcnt(0)
v_readfirstlane_b32 s34, v13
s_load_dwordx16 s[36:51], s[12:13], s21 offset:983040 glc
s_load_dwordx16 s[52:67], s[12:13], s21 offset:983104 glc
s_load_dwordx16 s[68:83], s[12:13], s21 offset:983168 glc
s_load_dwordx16 s[84:99], s[12:13], s21 offset:983232 glc
s_cmp_ge_u32 s34, 267
s_cbranch_scc1 S_dryend
s_branch S_wts
S_dryend:
s_mov_b32 s35, 1
s_mov_b32 m0, 8192
s_add_u32 s28, s100, 28672
buffer_load_dwordx4 v236, s[8:11], s28 offen nt lds
s_mov_b32 m0, 9216
s_add_u32 s28, s100, 32256
buffer_load_dwordx4 v236, s[8:11], s28 offen nt lds
s_mov_b32 m0, 10240
s_add_u32 s28, s100, 35840
buffer_load_dwordx4 v237, s[8:11], s28 offen nt lds
s_mov_b32 m0, 11264
s_add_u32 s28, s100, 39424
buffer_load_dwordx4 v237, s[8:11], s28 offen nt lds
s_mov_b32 m0, 12288
s_add_u32 s28, s100, 43008
buffer_load_dwordx4 v238, s[8:11], s28 offen nt lds
s_mov_b32 m0, 13312
s_add_u32 s28, s100, 46592
buffer_load_dwordx4 v238, s[8:11], s28 offen nt lds
s_mov_b32 m0, 14336
s_add_u32 s28, s100, 50176
buffer_load_dwordx4 v239, s[8:11], s28 offen nt lds
s_mov_b32 m0, 15360
s_add_u32 s28, s100, 53760
buffer_load_dwordx4 v239, s[8:11], s28 offen nt lds
s_mov_b32 s33, 25000
s_branch S_chk6
S_poll6:
s_mov_b32 s33, 25000
SP_75:
s_load_dwordx16 s[36:51], s[12:13], s21 offset:983040 glc
s_load_dwordx16 s[52:67], s[12:13], s21 offset:983104 glc
s_load_dwordx16 s[68:83], s[12:13], s21 offset:983168 glc
s_load_dwordx16 s[84:99], s[12:13], s21 offset:983232 glc
s_sub_u32 s33, s33, 1
s_cbranch_scc1 SE_76
S_chk6:
s_waitcnt lgkmcnt(0)
s_and_b64 s[28:29], s[36:37], s[38:39]
s_or_b64 s[30:31], s[36:37], s[38:39]
s_and_b64 s[28:29], s[28:29], s[40:41]
s_or_b64 s[30:31], s[30:31], s[40:41]
s_and_b64 s[28:29], s[28:29], s[42:43]
s_or_b64 s[30:31], s[30:31], s[42:43]
s_and_b64 s[28:29], s[28:29], s[44:45]
s_or_b64 s[30:31], s[30:31], s[44:45]
s_and_b64 s[28:29], s[28:29], s[46:47]
s_or_b64 s[30:31], s[30:31], s[46:47]
s_and_b64 s[28:29], s[28:29], s[48:49]
s_or_b64 s[30:31], s[30:31], s[48:49]
s_and_b64 s[28:29], s[28:29], s[50:51]
s_or_b64 s[30:31], s[30:31], s[50:51]
s_and_b64 s[28:29], s[28:29], s[52:53]
s_or_b64 s[30:31], s[30:31], s[52:53]
s_and_b64 s[28:29], s[28:29], s[54:55]
s_or_b64 s[30:31], s[30:31], s[54:55]
s_and_b64 s[28:29], s[28:29], s[56:57]
s_or_b64 s[30:31], s[30:31], s[56:57]
s_and_b64 s[28:29], s[28:29], s[58:59]
s_or_b64 s[30:31], s[30:31], s[58:59]
s_and_b64 s[28:29], s[28:29], s[60:61]
s_or_b64 s[30:31], s[30:31], s[60:61]
s_and_b64 s[28:29], s[28:29], s[62:63]
s_or_b64 s[30:31], s[30:31], s[62:63]
s_and_b64 s[28:29], s[28:29], s[64:65]
s_or_b64 s[30:31], s[30:31], s[64:65]
s_and_b64 s[28:29], s[28:29], s[66:67]
s_or_b64 s[30:31], s[30:31], s[66:67]
s_and_b64 s[28:29], s[28:29], s[68:69]
s_or_b64 s[30:31], s[30:31], s[68:69]
s_and_b64 s[28:29], s[28:29], s[70:71]
s_or_b64 s[30:31], s[30:31], s[70:71]
s_and_b64 s[28:29], s[28:29], s[72:73]
s_or_b64 s[30:31], s[30:31], s[72:73]
s_and_b64 s[28:29], s[28:29], s[74:75]
s_or_b64 s[30:31], s[30:31], s[74:75]
s_and_b64 s[28:29], s[28:29], s[76:77]
s_or_b64 s[30:31], s[30:31], s[76:77]
s_and_b64 s[28:29], s[28:29], s[78:79]
s_or_b64 s[30:31], s[30:31], s[78:79]
s_and_b64 s[28:29], s[28:29], s[80:81]
s_or_b64 s[30:31], s[30:31], s[80:81]
s_and_b64 s[28:29], s[28:29], s[82:83]
s_or_b64 s[30:31], s[30:31], s[82:83]
s_and_b64 s[28:29], s[28:29], s[84:85]
s_or_b64 s[30:31], s[30:31], s[84:85]
s_and_b64 s[28:29], s[28:29], s[86:87]
s_or_b64 s[30:31], s[30:31], s[86:87]
s_and_b64 s[28:29], s[28:29], s[88:89]
s_or_b64 s[30:31], s[30:31], s[88:89]
s_and_b64 s[28:29], s[28:29], s[90:91]
s_or_b64 s[30:31], s[30:31], s[90:91]
s_and_b64 s[28:29], s[28:29], s[92:93]
s_or_b64 s[30:31], s[30:31], s[92:93]
s_and_b64 s[28:29], s[28:29], s[94:95]
s_or_b64 s[30:31], s[30:31], s[94:95]
s_and_b64 s[28:29], s[28:29], s[96:97]
s_or_b64 s[30:31], s[30:31], s[96:97]
s_and_b64 s[28:29], s[28:29], s[98:99]
s_or_b64 s[30:31], s[30:31], s[98:99]
s_xor_b32 s28, s29, s16
s_xor_b32 s30, s31, s16
s_or_b32 s28, s28, s30
s_and_b32 s28, s28, -1
s_cbranch_scc1 SP_75
SE_76:
s_waitcnt lgkmcnt(0)
s_mov_b32 m0, 81920
s_nop 0
buffer_load_dwordx4 v18, s[12:15], s20 offen offset:0 sc1 lds
s_mov_b32 m0, 81920
s_nop 0
buffer_load_dwordx4 v18, s[12:15], s20 offen offset:1024 sc1 lds
s_mov_b32 m0, 81920
s_nop 0
buffer_load_dwordx4 v18, s[12:15], s20 offen offset:2048 sc1 lds
s_mov_b32 m0, 81920
s_nop 0
buffer_load_dwordx4 v18, s[12:15], s20 offen offset:3072 sc1 lds
S_wts:
s_mov_b32 exec_lo, 0xffff
s_mov_b32 exec_hi, 0x0
v_mov_b32 v64, s36
v_mov_b32 v65, s38
v_mov_b32 v66, s40
v_mov_b32 v67, s42
v_mov_b32 v68, s44
v_mov_b32 v69, s46
v_mov_b32 v70, s48
v_mov_b32 v71, s50
s_mov_b32 exec_lo, 0xffff0000
s_mov_b32 exec_hi, 0x0
v_mov_b32 v64, s52
v_mov_b32 v65, s54
v_mov_b32 v66, s56
v_mov_b32 v67, s58
v_mov_b32 v68, s60
v_mov_b32 v69, s62
v_mov_b32 v70, s64
v_mov_b32 v71, s66
s_mov_b32 exec_lo, 0x0
s_mov_b32 exec_hi, 0xffff
v_mov_b32 v64, s68
v_mov_b32 v65, s70
v_mov_b32 v66, s72
v_mov_b32 v67, s74
v_mov_b32 v68, s76
v_mov_b32 v69, s78
v_mov_b32 v70, s80
v_mov_b32 v71, s82
s_mov_b32 exec_lo, 0x0
s_mov_b32 exec_hi, 0xffff0000
v_mov_b32 v64, s84
v_mov_b32 v65, s86
v_mov_b32 v66, s88
v_mov_b32 v67, s90
v_mov_b32 v68, s92
v_mov_b32 v69, s94
v_mov_b32 v70, s96
v_mov_b32 v71, s98
s_mov_b64 exec, -1
v_max3_f32 v72, v64, v65, v66
v_max3_f32 v73, v67, v68, v69
v_max3_f32 v72, v72, v70, v71
v_max_f32 v72, v72, v73
v_mov_b32 v73, v72
s_nop 1
v_permlane16_swap_b32 v72, v73
v_max_f32 v72, v72, v73
v_mov_b32 v73, v72
s_nop 1
v_permlane32_swap_b32 v72, v73
v_max_f32 v72, v72, v73
v_sub_f32 v64, v64, v72
v_sub_f32 v65, v65, v72
v_sub_f32 v66, v66, v72
v_sub_f32 v67, v67, v72
v_sub_f32 v68, v68, v72
v_sub_f32 v69, v69, v72
v_sub_f32 v70, v70, v72
v_sub_f32 v71, v71, v72
v_exp_f32 v64, v64
v_exp_f32 v65, v65
v_exp_f32 v66, v66
v_exp_f32 v67, v67
v_exp_f32 v68, v68
v_exp_f32 v69, v69
v_exp_f32 v70, v70
v_exp_f32 v71, v71
v_add_f32 v73, v64, v65
v_add_f32 v74, v66, v67
v_add_f32 v75, v68, v69
v_add_f32 v76, v70, v71
v_add_f32 v73, v73, v74
v_add_f32 v75, v75, v76
v_add_f32 v73, v73, v75
v_mov_b32 v74, v73
s_nop 1
v_permlane16_swap_b32 v73, v74
v_add_f32 v73, v73, v74
v_mov_b32 v74, v73
s_nop 1
v_permlane32_swap_b32 v73, v74
v_add_f32 v73, v73, v74
v_rcp_f32 v73, v73
s_nop 0
v_mul_f32 v64, v64, v73
v_mul_f32 v65, v65, v73
v_mul_f32 v66, v66, v73
v_mul_f32 v67, v67, v73
v_mul_f32 v68, v68, v73
v_mul_f32 v69, v69, v73
v_mul_f32 v70, v70, v73
v_mul_f32 v71, v71, v73
v_cvt_pk_bf16_f32 v88, v64, v65
v_cvt_pk_bf16_f32 v89, v66, v67
v_cvt_pk_bf16_f32 v90, v68, v69
v_cvt_pk_bf16_f32 v91, v70, v71
s_cmp_eq_u32 s35, 0
s_cbranch_scc1 S_nowait
s_cmp_lg_u32 s35, 1
s_cbranch_scc1 S_wodone
s_waitcnt vmcnt(4)
v_xor_b32 v24, 0, v108
ds_read_b64_tr_b16 v[192:193], v24 offset:0
ds_read_b64_tr_b16 v[194:195], v24 offset:1024
ds_read_b64_tr_b16 v[196:197], v24 offset:8192
ds_read_b64_tr_b16 v[198:199], v24 offset:9216
v_xor_b32 v25, 32, v108
ds_read_b64_tr_b16 v[200:201], v25 offset:0
ds_read_b64_tr_b16 v[202:203], v25 offset:1024
ds_read_b64_tr_b16 v[204:205], v25 offset:8192
ds_read_b64_tr_b16 v[206:207], v25 offset:9216
v_xor_b32 v26, 64, v108
ds_read_b64_tr_b16 v[208:209], v26 offset:0
ds_read_b64_tr_b16 v[210:211], v26 offset:1024
ds_read_b64_tr_b16 v[212:213], v26 offset:8192
ds_read_b64_tr_b16 v[214:215], v26 offset:9216
v_xor_b32 v27, 96, v108
ds_read_b64_tr_b16 v[216:217], v27 offset:0
ds_read_b64_tr_b16 v[218:219], v27 offset:1024
ds_read_b64_tr_b16 v[220:221], v27 offset:8192
ds_read_b64_tr_b16 v[222:223], v27 offset:9216
v_xor_b32 v24, 128, v108
ds_read_b64_tr_b16 v[224:225], v24 offset:0
ds_read_b64_tr_b16 v[226:227], v24 offset:1024
ds_read_b64_tr_b16 v[228:229], v24 offset:8192
ds_read_b64_tr_b16 v[230:231], v24 offset:9216
v_xor_b32 v25, 160, v108
ds_read_b64_tr_b16 v[232:233], v25 offset:0
ds_read_b64_tr_b16 v[234:235], v25 offset:1024
ds_read_b64_tr_b16 v[236:237], v25 offset:8192
ds_read_b64_tr_b16 v[238:239], v25 offset:9216
v_xor_b32 v26, 192, v108
ds_read_b64_tr_b16 v[240:241], v26 offset:0
ds_read_b64_tr_b16 v[242:243], v26 offset:1024
ds_read_b64_tr_b16 v[244:245], v26 offset:8192
ds_read_b64_tr_b16 v[246:247], v26 offset:9216
v_xor_b32 v27, 224, v108
ds_read_b64_tr_b16 v[248:249], v27 offset:0
ds_read_b64_tr_b16 v[250:251], v27 offset:1024
ds_read_b64_tr_b16 v[252:253], v27 offset:8192
ds_read_b64_tr_b16 v[254:255], v27 offset:9216
s_mov_b32 s35, 2
S_wodone:
s_waitcnt vmcnt(0)
S_nowait:
ds_read_b64_tr_b16 v[112:113], v107 offset:0
ds_read_b64_tr_b16 v[114:115], v107 offset:512
ds_read_b64_tr_b16 v[116:117], v107 offset:32
ds_read_b64_tr_b16 v[118:119], v107 offset:544
ds_read_b64_tr_b16 v[120:121], v107 offset:64
ds_read_b64_tr_b16 v[122:123], v107 offset:576
ds_read_b64_tr_b16 v[124:125], v107 offset:96
ds_read_b64_tr_b16 v[126:127], v107 offset:608
s_waitcnt lgkmcnt(6)
v_xor_b32 v112, v152, v112
v_xor_b32 v113, v152, v113
v_xor_b32 v114, v152, v114
v_xor_b32 v115, v152, v115
s_waitcnt lgkmcnt(4)
v_xor_b32 v116, v153, v116
v_xor_b32 v117, v153, v117
v_xor_b32 v118, v153, v118
v_xor_b32 v119, v153, v119
v_mfma_f32_16x16x32_bf16 v[128:131], v[112:115], v[88:91], 0
s_waitcnt lgkmcnt(2)
v_xor_b32 v120, v152, v120
v_xor_b32 v121, v152, v121
v_xor_b32 v122, v152, v122
v_xor_b32 v123, v152, v123
v_mfma_f32_16x16x32_bf16 v[132:135], v[116:119], v[88:91], 0
s_waitcnt lgkmcnt(0)
v_xor_b32 v124, v153, v124
v_xor_b32 v125, v153, v125
v_xor_b32 v126, v153, v126
v_xor_b32 v127, v153, v127
v_mfma_f32_16x16x32_bf16 v[136:139], v[120:123], v[88:91], 0
v_or_b32 v15, v112, v113
v_or3_b32 v15, v114, v115, v15
v_mfma_f32_16x16x32_bf16 v[140:143], v[124:127], v[88:91], 0
v_or3_b32 v15, v116, v117, v15
v_or3_b32 v15, v118, v119, v15
v_or3_b32 v15, v120, v121, v15
v_or3_b32 v15, v122, v123, v15
v_or3_b32 v15, v124, v125, v15
v_or3_b32 v15, v126, v127, v15
v_and_b32 v14, 0x00010001, v15
v_cmp_ne_u32 vcc, 0, v14
v_cvt_pk_bf16_f32 v144, v128, v129
v_cvt_pk_bf16_f32 v145, v130, v131
v_cvt_pk_bf16_f32 v146, v132, v133
v_cvt_pk_bf16_f32 v147, v134, v135
v_cvt_pk_bf16_f32 v148, v136, v137
v_cvt_pk_bf16_f32 v149, v138, v139
v_cvt_pk_bf16_f32 v150, v140, v141
v_cvt_pk_bf16_f32 v151, v142, v143
v_mfma_f32_16x16x32_bf16 v[32:35], v[144:147], v[192:195], 0
v_mfma_f32_16x16x32_bf16 v[36:39], v[144:147], v[200:203], 0
v_mfma_f32_16x16x32_bf16 v[40:43], v[144:147], v[208:211], 0
v_mfma_f32_16x16x32_bf16 v[44:47], v[144:147], v[216:219], 0
v_mfma_f32_16x16x32_bf16 v[48:51], v[144:147], v[224:227], 0
v_mfma_f32_16x16x32_bf16 v[52:55], v[144:147], v[232:235], 0
v_mfma_f32_16x16x32_bf16 v[56:59], v[144:147], v[240:243], 0
v_mfma_f32_16x16x32_bf16 v[60:63], v[144:147], v[248:251], 0
v_mfma_f32_16x16x32_bf16 v[32:35], v[148:151], v[196:199], v[32:35]
v_mfma_f32_16x16x32_bf16 v[36:39], v[148:151], v[204:207], v[36:39]
v_mfma_f32_16x16x32_bf16 v[40:43], v[148:151], v[212:215], v[40:43]
v_mfma_f32_16x16x32_bf16 v[44:47], v[148:151], v[220:223], v[44:47]
v_mfma_f32_16x16x32_bf16 v[48:51], v[148:151], v[228:231], v[48:51]
v_mfma_f32_16x16x32_bf16 v[52:55], v[148:151], v[236:239], v[52:55]
v_mfma_f32_16x16x32_bf16 v[56:59], v[148:151], v[244:247], v[56:59]
v_mfma_f32_16x16x32_bf16 v[60:63], v[148:151], v[252:255], v[60:63]
s_cmp_eq_u32 s35, 0
s_cbranch_scc1 S_dryend
s_cbranch_vccz S_ok6
s_sub_u32 s25, s25, 1
s_cbranch_scc1 S_ok6
s_and_b32 s28, s25, 3
s_cbranch_scc0 S_poll6
s_mov_b32 m0, 81920
s_nop 0
buffer_load_dwordx4 v18, s[12:15], s20 offen offset:0 sc1 lds
buffer_load_dwordx4 v18, s[12:15], s20 offen offset:1024 sc1 lds
buffer_load_dwordx4 v18, s[12:15], s20 offen offset:2048 sc1 lds
buffer_load_dwordx4 v18, s[12:15], s20 offen offset:3072 sc1 lds
s_branch S_wodone
S_ok6:
s_mov_b64 exec, 0xffff
v_and_or_b32 v20, v32, v19, v96
v_and_or_b32 v21, v36, v19, v97
v_and_or_b32 v22, v40, v19, v98
v_and_or_b32 v23, v44, v19, v99
s_mov_b32 exec_lo, 0xffff0000
v_and_or_b32 v20, v48, v19, v96
v_and_or_b32 v21, v52, v19, v97
v_and_or_b32 v22, v56, v19, v98
v_and_or_b32 v23, v60, v19, v99
s_mov_b32 exec_lo, s24
buffer_store_dwordx4 v[20:23], v18, s[12:15], s23 offen sc1
s_mov_b64 exec, -1
s_cmp_ge_u32 s7, 112
s_cbranch_scc1 S_0end
s_mov_b32 s8, s26
s_mov_b32 s9, s27
s_mov_b32 s10, 1792
s_mov_b32 s11, 0x00020000
s_mov_b32 s33, 25000
RO_77:
buffer_load_dwordx4 v[20:23], v28, s[12:15], s4 offen sc1
s_sub_u32 s33, s33, 1
s_cbranch_scc1 RE_78
s_waitcnt vmcnt(0)
v_xor_b32 v15, v96, v20
v_bitop3_b32 v15, v21, v97, v15 bitop3:0xbe
v_bitop3_b32 v15, v22, v98, v15 bitop3:0xbe
v_bitop3_b32 v15, v23, v99, v15 bitop3:0xbe
v_and_b32 v14, 0xff, v15
v_cmp_ne_u32 vcc, 0, v14
v_and_b32 v20, v19, v20
v_and_b32 v21, v19, v21
v_and_b32 v22, v19, v22
v_and_b32 v23, v19, v23
s_nop 0
s_cbranch_vccnz RO_77
RE_78:
s_waitcnt vmcnt(0)
v_permlane32_swap_b32 v20, v21
v_permlane32_swap_b32 v22, v23
v_add_f32 v20, v20, v21
v_add_f32 v22, v22, v23
s_nop 1
v_permlane16_swap_b32 v20, v22
v_add_f32 v20, v20, v22
s_nop 1
v_add_f32 v20, v20, v20 row_ror:8 row_mask:0xf bank_mask:0xf
s_nop 1
v_add_f32 v20, v20, v20 row_ror:4 row_mask:0xf bank_mask:0xf
s_nop 1
v_add_f32 v20, v20, v20 row_ror:2 row_mask:0xf bank_mask:0xf
s_nop 1
v_add_f32 v20, v20, v20 row_ror:1 row_mask:0xf bank_mask:0xf
v_cvt_pk_bf16_f32 v20, v20, v20
s_mov_b32 exec_lo, 0x00010001
s_mov_b32 exec_hi, 0x00010001
buffer_store_short v20, v29, s[8:11], s5 offen
s_mov_b64 exec, -1
s_cmp_lg_u32 s2, 0
s_cbranch_scc1 S_0end
v_mov_b32 v20, s16
v_mov_b32 v21, 0
s_mov_b64 exec, 1
buffer_store_dword v20, v21, s[12:15], 0 offen sc1
s_mov_b64 exec, -1
S_0end:
L_end:
s_endpgm
L_codeend:
.set CODE_BYTES, L_codeend - concat_heads__gqa_block_cached__compressed_kv_cla__decode_kernel
.section .rodata,"a"
.p2align 6
.amdhsa_kernel concat_heads__gqa_block_cached__compressed_kv_cla__decode_kernel
  .amdhsa_next_free_vgpr 256
  .amdhsa_next_free_sgpr 102
  .amdhsa_accum_offset 256
  .amdhsa_group_segment_fixed_size 0
  .amdhsa_kernarg_size 112
  .amdhsa_user_sgpr_count 2
  .amdhsa_user_sgpr_kernarg_segment_ptr 1
  .amdhsa_system_sgpr_workgroup_id_x 1
.end_amdhsa_kernel
```
